```python
import torch

def _softmax(x, axis=-1):
    return torch.softmax(x, dim=axis)
def _gelu(x):
    return torch.nn.functional.gelu(x, approximate="tanh")
def _silu(x):
    return torch.nn.functional.silu(x)
def _sigmoid(x):
    return torch.sigmoid(x)
def _layernorm(x, axis=-1, eps=1e-5):
    m = x.mean(dim=axis, keepdim=True)
    v = x.var(dim=axis, keepdim=True, unbiased=False)
    return (x - m) / torch.sqrt(v + eps)
def _scatter_add(tgt, idx, src, axis=0):
    return tgt.clone().index_add_(axis, idx, src)
def _segment_sum(src, seg, n):
    out = torch.zeros((n,) + src.shape[1:], dtype=src.dtype)
    return out.index_add_(0, seg, src)
def _pad(x, pw):
    flat = tuple(v for pair in reversed(pw) for v in pair)
    return torch.nn.functional.pad(x, flat)

kernel_name = 'gated_mix__ssm_conv_s4__glu_gated_bilinear__prompt'

def setup_inputs():

    _w = (lambda a: (lambda t: t.to(torch.bfloat16) if t.is_floating_point() else t)(torch.as_tensor(a)))
    def _A_setup():
        B, L, D, N = 1, 2048, 640, 192
        A_re = -(lambda _x: torch.exp(torch.as_tensor(_x)))((lambda *s: torch.randn(*s, dtype=torch.bfloat16) * 6.4)(D, N))
        A_im = torch.pi * (lambda *s: torch.randn(*s, dtype=torch.bfloat16) * 0.05)(D, N)
        B_re = (lambda *s: torch.randn(*s, dtype=torch.bfloat16) * 0.05)(D, N)
        B_im = (lambda *s: torch.randn(*s, dtype=torch.bfloat16) * 0.05)(D, N)
        C_re = (lambda *s: torch.randn(*s, dtype=torch.bfloat16) * 0.05)(D, N)
        C_im = (lambda *s: torch.randn(*s, dtype=torch.bfloat16) * 0.05)(D, N)
        log_dt = (lambda *s: torch.randn(*s, dtype=torch.bfloat16) * 0.05)(D) * 0.5 - 4.0
        Dskip = (lambda *s: torch.randn(*s, dtype=torch.bfloat16) * 0.05)(D)
        return {
            "u": _w((lambda *s: torch.randn(*s, dtype=torch.bfloat16) * 0.05)(B, L, D)),
            "A_re": _w(A_re),
            "A_im": _w(A_im),
            "B_re": _w(B_re),
            "B_im": _w(B_im),
            "C_re": _w(C_re),
            "C_im": _w(C_im),
            "log_dt": _w(log_dt),
            "Dskip": _w(Dskip),
        }
    _A_in = _A_setup()

    def _B_setup():
        B, S, D, F = 1, 2048, 640, 1536
        return {
            "x": _w((lambda *s: torch.randn(*s, dtype=torch.bfloat16) * 0.05)(B, S, D)),
            "w_gate": _w((lambda *s: torch.randn(*s, dtype=torch.bfloat16) * 0.8)(D, F) * (D ** -0.5)),
            "w_up": _w((lambda *s: torch.randn(*s, dtype=torch.bfloat16) * 0.8)(D, F) * (D ** -0.5)),
            "w_down": _w((lambda *s: torch.randn(*s, dtype=torch.bfloat16) * 0.8)(F, D) * (F ** -0.5)),
        }
    _B_in = _B_setup()

    return {
        "A_u": _A_in["u"],
        "A_A_re": _A_in["A_re"],
        "A_A_im": _A_in["A_im"],
        "A_B_re": _A_in["B_re"],
        "A_B_im": _A_in["B_im"],
        "A_C_re": _A_in["C_re"],
        "A_C_im": _A_in["C_im"],
        "A_log_dt": _A_in["log_dt"],
        "A_Dskip": _A_in["Dskip"],
        "B_x": _B_in["x"],
        "B_w_gate": _B_in["w_gate"],
        "B_w_up": _B_in["w_up"],
        "B_w_down": _B_in["w_down"],
        "gate_w": _w((lambda *s: torch.randn(*s, dtype=torch.bfloat16) * 0.05)(640) * 16.0),
    }

def reference(A_u, A_A_re, A_A_im, A_B_re, A_B_im, A_C_re, A_C_im, A_log_dt, A_Dskip, B_x, B_w_gate, B_w_up, B_w_down, gate_w):
    def _A_ref(u, A_re, A_im, B_re, B_im, C_re, C_im, log_dt, Dskip):
        Bsz, L, D = u.shape
        dt = torch.exp(log_dt)[:, None]
        A = A_re + 1j * A_im
        Bc = B_re + 1j * B_im
        Cc = C_re + 1j * C_im
        logdA = dt * A
        dB = dt * Bc
        l = (lambda x, dt: x.to(dt))(torch.arange(L), A_re.dtype)
        P = torch.exp(logdA[:, :, None] * l[None, None, :])
        K = torch.einsum("dn,dnl,dn->dl", Cc, P, dB).real
        L2 = 2 * L
        Kp = _pad(K, ((0, 0), (0, L)))
        up = (lambda x, *d: x.permute(*d))(u, 0, 2, 1)
        up = _pad(up, ((0, 0), (0, 0), (0, L)))
        Kf = (lambda x, axes=(-2,-1): torch.fft.rfft2(x.float(), dim=axes))(Kp[:, None, :], axes=(-2, -1))
        Uf = (lambda x, axes=(-2,-1): torch.fft.rfft2(x.float(), dim=axes))(up[:, :, None, :], axes=(-2, -1))
        Yf = Uf * Kf[None, :, :, :]
        y = (lambda x, s, axes=(-2,-1): torch.fft.irfft2(x, s=s, dim=axes).to(torch.bfloat16))(Yf, (1, L2), axes=(-2, -1))[:, :, 0, :L]
        y = (lambda x, *d: x.permute(*d))(y, 0, 2, 1) + u * Dskip[None, None, :]
        return y

    def _B_ref(x, w_gate, w_up, w_down):
        g = torch.einsum("bsd,df->bsf", x, w_gate)
        u = torch.einsum("bsd,df->bsf", x, w_up)
        h = g * u
        return torch.einsum("bsf,fd->bsd", h, w_down)

    x = A_u
    g = _sigmoid((x * gate_w).sum(-1, keepdims=True))
    a = _A_ref(x, A_A_re, A_A_im, A_B_re, A_B_im, A_C_re, A_C_im, A_log_dt, A_Dskip)
    b = _B_ref(x, B_w_gate, B_w_up, B_w_down)
    return g * a + (1 - g) * b
```

```asm
; @launch grid=(512,1,1) block=(256,1,1) lds=81920
.amdgcn_target "amdgcn-amd-amdhsa--gfx950"
.text
.globl gated_mix__ssm_conv_s4__glu_gated_bilinear__prompt_kernel
.p2align 8
.type gated_mix__ssm_conv_s4__glu_gated_bilinear__prompt_kernel,@function
gated_mix__ssm_conv_s4__glu_gated_bilinear__prompt_kernel:
s_cmp_ge_u32 s2, 512
s_cbranch_scc1 L_exit
s_load_dwordx16 s[16:31], s[0:1], 0
s_load_dwordx16 s[32:47], s[0:1], 64
s_load_dwordx2 s[48:49], s[0:1], 128
v_lshrrev_b32 v2, 6, v0
v_and_b32 v1, 63, v0
s_and_b32 s3, s2, 7
v_readfirstlane_b32 s5, v2
s_bfe_u32 s4, s2, 0x50003
s_cmp_lt_u32 s2, 256
s_cbranch_scc1 L_F
s_cmp_ge_u32 s4, 12
s_cbranch_scc1 L_C
s_cmp_ge_u32 s4, 8
s_cbranch_scc1 L_W
s_branch L_T
L_exit:
s_endpgm
.p2align 3
L_F:
s_getpc_b64 s[6:7]
L_F_pc:
s_sub_u32 s8, s4, 0
s_lshl_b32 s8, s8, 2
s_add_u32 s8, s8, s5
s_lshl_b32 s8, s8, 7
s_min_u32 s8, s8, L_F_end-L_F_pc-4
v_mov_b32 v3, s8
global_load_dword v255, v3, s[6:7]
s_setprio 1
s_lshl_b32 s98, s3, 7
s_add_u32 s98, s98, 14757888
v_lshlrev_b32 v253, 2, v1
s_and_b32 s10, s3, 3
s_lshl_b32 s10, s10, 2
s_and_b32 s11, s4, 3
s_add_u32 s10, s10, s11
s_lshr_b32 s11, s3, 2
s_lshl_b32 s11, s11, 3
s_lshr_b32 s12, s4, 2
s_add_u32 s11, s11, s12
s_and_b32 s12, s5, 1
s_lshr_b32 s13, s5, 1
s_mul_i32 s14, s12, 192
s_lshl_b32 s15, s13, 1
s_mul_i32 s50, s10, 192
s_mov_b32 s51, 0x15555556
v_add_u32 v2, s14, v1
v_mul_hi_u32 v3, v2, s51
v_mul_u32_u24 v4, 12, v3
v_sub_u32 v4, v2, v4
v_xor_b32 v4, s15, v4
v_lshlrev_b32 v4, 4, v4
v_mul_u32_u24 v3, 3072, v3
v_add3_u32 v215, v3, v4, s50
s_sub_u32 s50, s50, 1024
v_add_u32 v2, 64, v2
v_mul_hi_u32 v3, v2, s51
v_mul_u32_u24 v4, 12, v3
v_sub_u32 v4, v2, v4
v_xor_b32 v4, s15, v4
v_lshlrev_b32 v4, 4, v4
v_mul_u32_u24 v3, 3072, v3
v_add3_u32 v216, v3, v4, s50
s_sub_u32 s50, s50, 1024
v_add_u32 v2, 64, v2
v_mul_hi_u32 v3, v2, s51
v_mul_u32_u24 v4, 12, v3
v_sub_u32 v4, v2, v4
v_xor_b32 v4, s15, v4
v_lshlrev_b32 v4, 4, v4
v_mul_u32_u24 v3, 3072, v3
v_add3_u32 v217, v3, v4, s50
s_lshl_b32 s14, s11, 2
s_add_u32 s14, s14, s5
s_mul_i32 s14, s14, 40960
v_lshrrev_b32 v2, 3, v1
v_mul_u32_u24 v2, 1280, v2
v_and_b32 v3, 7, v1
v_lshrrev_b32 v4, 4, v1
v_xor_b32 v3, v3, v4
v_lshlrev_b32 v3, 4, v3
v_xor_b32 v5, 64, v3
v_add3_u32 v218, v2, v3, s14
s_add_u32 s14, s14, 9216
v_add3_u32 v219, v2, v5, s14
v_add_u32 v220, 18432, v218
v_add_u32 v221, 18432, v219
s_mov_b32 s99, 0
s_mov_b32 s100, 0
s_mul_i32 s70, s5, 3072
s_lshl_b32 s71, s5, 12
s_add_u32 s71, s71, 49152
s_cmp_eq_u32 s13, 0
s_waitcnt lgkmcnt(0)
s_cselect_b32 s64, s36, s38
s_cselect_b32 s65, s37, s39
s_mov_b32 s66, 1966080
s_mov_b32 s67, 0x20000
s_mov_b32 s60, s16
s_mov_b32 s61, s17
s_mov_b32 s62, 2621440
s_mov_b32 s63, 0x20000
s_add_u32 m0, s70, 0
s_nop 0
buffer_load_dwordx4 v215, s[64:67], s99 offen offset:0 lds
buffer_load_dwordx4 v216, s[64:67], s99 offen offset:1024 lds
buffer_load_dwordx4 v217, s[64:67], s99 offen offset:2048 lds
s_add_u32 m0, s71, 0
s_nop 0
buffer_load_dwordx4 v218, s[60:63], s100 offen offset:0 lds
buffer_load_dwordx4 v219, s[60:63], s100 offen offset:1024 lds
buffer_load_dwordx4 v220, s[60:63], s100 offen offset:2048 lds
buffer_load_dwordx4 v221, s[60:63], s100 offen offset:3072 lds
s_add_u32 m0, s70, 12288
s_add_u32 s99, s99, 98304
buffer_load_dwordx4 v215, s[64:67], s99 offen offset:0 lds
buffer_load_dwordx4 v216, s[64:67], s99 offen offset:1024 lds
buffer_load_dwordx4 v217, s[64:67], s99 offen offset:2048 lds
s_mov_b32 s52, s48
s_mov_b32 s53, s49
s_mov_b32 s54, 16777216
s_mov_b32 s55, 0x20000
s_mov_b32 s56, s46
s_mov_b32 s57, s47
s_mov_b32 s58, 256
s_mov_b32 s59, 0x20000
s_mov_b32 s76, s44
s_mov_b32 s77, s45
s_mov_b32 s78, 2621440
s_mov_b32 s79, 0x20000
v_bfe_u32 v2, v1, 4, 1
v_lshrrev_b32 v3, 5, v1
v_bfe_u32 v4, v1, 2, 2
v_lshl_add_u32 v4, v3, 3, v4
v_mul_u32_u24 v4, 192, v4
v_mul_u32_u24 v5, 6144, v2
v_and_b32 v6, 3, v1
v_lshlrev_b32 v6, 3, v6
v_add3_u32 v4, v4, v5, v6
s_mul_i32 s14, s13, 3
v_xor_b32 v5, s14, v2
v_lshl_add_u32 v208, v5, 5, v4
s_add_u32 s14, s14, 1
v_xor_b32 v5, s14, v2
v_lshl_add_u32 v209, v5, 5, v4
s_add_u32 s14, s14, 1
v_xor_b32 v5, s14, v2
v_lshl_add_u32 v210, v5, 5, v4
s_add_u32 s14, s14, 1
v_and_b32 v4, 31, v1
v_bfe_u32 v5, v1, 1, 3
v_xor_b32 v5, v5, v3
v_lshlrev_b32 v4, 7, v4
s_lshl_b32 s14, s12, 13
s_add_u32 s14, s14, 49152
v_add_u32 v4, s14, v4
v_xor_b32 v6, 0, v5
v_lshl_add_u32 v211, v6, 4, v4
v_xor_b32 v6, 2, v5
v_lshl_add_u32 v212, v6, 4, v4
v_xor_b32 v6, 4, v5
v_lshl_add_u32 v213, v6, 4, v4
v_xor_b32 v6, 6, v5
v_lshl_add_u32 v214, v6, 4, v4
v_lshlrev_b32 v244, 4, v1
s_lshl_b32 s68, s3, 2
s_lshr_b32 s69, s4, 3
s_add_u32 s68, s68, s69
s_and_b32 s69, s4, 7
s_lshl_b32 s74, s69, 2
s_add_u32 s74, s74, s5
s_mul_i32 s74, s74, 61440
s_add_u32 s74, s74, 6291456
s_lshl_b32 s75, s68, 2
s_add_u32 s75, s75, s5
s_mul_i32 s75, s75, 49152
s_mul_i32 s18, s3, 3
s_lshr_b32 s18, s18, 1
s_lshl_b32 s18, s18, 10
s_cmp_ge_u32 s18, 12288
s_cselect_b32 s14, 12288, 0
s_sub_u32 s18, s18, s14
s_add_u32 s19, s18, 1024
s_cmp_eq_u32 s19, 12288
s_cselect_b32 s19, 0, s19
s_add_u32 s20, s19, 1024
s_cmp_eq_u32 s20, 12288
s_cselect_b32 s20, 0, s20
s_add_u32 s21, s20, 1024
s_cmp_eq_u32 s21, 12288
s_cselect_b32 s21, 0, s21
s_add_u32 s22, s21, 1024
s_cmp_eq_u32 s22, 12288
s_cselect_b32 s22, 0, s22
s_add_u32 s23, s22, 1024
s_cmp_eq_u32 s23, 12288
s_cselect_b32 s23, 0, s23
s_add_u32 s24, s23, 1024
s_cmp_eq_u32 s24, 12288
s_cselect_b32 s24, 0, s24
s_add_u32 s25, s24, 1024
s_cmp_eq_u32 s25, 12288
s_cselect_b32 s25, 0, s25
s_add_u32 s26, s25, 1024
s_cmp_eq_u32 s26, 12288
s_cselect_b32 s26, 0, s26
s_add_u32 s27, s26, 1024
s_cmp_eq_u32 s27, 12288
s_cselect_b32 s27, 0, s27
s_add_u32 s28, s27, 1024
s_cmp_eq_u32 s28, 12288
s_cselect_b32 s28, 0, s28
s_add_u32 s29, s28, 1024
s_cmp_eq_u32 s29, 12288
s_cselect_b32 s29, 0, s29
v_lshlrev_b32 v4, 11, v3
v_lshl_add_u32 v4, v2, 9, v4
v_and_b32 v5, 15, v1
v_lshl_add_u32 v4, v5, 4, v4
s_lshl_b32 s14, s12, 8
s_lshl_b32 s15, s13, 10
s_add_u32 s14, s14, s15
v_add_u32 v245, s14, v4
v_xor_b32 v246, 256, v245
v_xor_b32 v247, 1024, v245
v_xor_b32 v248, 1280, v245
v_add_u32 v249, s70, v244
v_add_u32 v250, s71, v244
v_mov_b32 v251, v1
s_lshl_b32 s50, s11, 1
s_add_u32 s50, s50, s12
s_lshl_b32 s50, s50, 4
s_add_u32 s50, s50, s10
s_lshl_b32 s50, s50, 1
s_add_u32 s50, s50, s13
s_mul_i32 s50, s50, 6144
s_add_u32 s51, s50, 4096
s_waitcnt vmcnt(3)
s_barrier
ds_read_b128 v[144:147], v211 offset:0
ds_read_b128 v[160:163], v211 offset:4096
ds_read_b128 v[148:151], v212 offset:0
ds_read_b128 v[164:167], v212 offset:4096
ds_read_b128 v[152:155], v213 offset:0
ds_read_b128 v[168:171], v213 offset:4096
ds_read_b128 v[156:159], v214 offset:0
ds_read_b128 v[172:175], v214 offset:4096
ds_read_b64_tr_b16 v[96:97], v208 offset:0
ds_read_b64_tr_b16 v[98:99], v208 offset:768
ds_read_b64_tr_b16 v[104:105], v209 offset:0
ds_read_b64_tr_b16 v[106:107], v209 offset:768
s_waitcnt lgkmcnt(6)
ds_read_b64_tr_b16 v[112:113], v210 offset:0
ds_read_b64_tr_b16 v[114:115], v210 offset:768
ds_read_b64_tr_b16 v[100:101], v208 offset:3072
ds_read_b64_tr_b16 v[102:103], v208 offset:3840
ds_read_b64_tr_b16 v[108:109], v209 offset:3072
ds_read_b64_tr_b16 v[110:111], v209 offset:3840
ds_read_b64_tr_b16 v[116:117], v210 offset:3072
ds_read_b64_tr_b16 v[118:119], v210 offset:3840
s_add_u32 m0, s70, 24576
s_add_u32 s99, s99, 98304
s_cmp_eq_u32 s99, 1966080
s_cselect_b32 s99, 0, s99
buffer_load_dwordx4 v215, s[64:67], s99 offen offset:0 lds
buffer_load_dwordx4 v216, s[64:67], s99 offen offset:1024 lds
buffer_load_dwordx4 v217, s[64:67], s99 offen offset:2048 lds
s_add_u32 m0, s71, 16384
s_add_u32 s100, s100, 128
s_cmp_eq_u32 s100, 1280
s_cselect_b32 s100, 0, s100
buffer_load_dwordx4 v218, s[60:63], s100 offen offset:0 lds
buffer_load_dwordx4 v219, s[60:63], s100 offen offset:1024 lds
buffer_load_dwordx4 v220, s[60:63], s100 offen offset:2048 lds
buffer_load_dwordx4 v221, s[60:63], s100 offen offset:3072 lds
s_add_u32 m0, s70, 36864
s_add_u32 s99, s99, 98304
buffer_load_dwordx4 v215, s[64:67], s99 offen offset:0 lds
buffer_load_dwordx4 v216, s[64:67], s99 offen offset:1024 lds
buffer_load_dwordx4 v217, s[64:67], s99 offen offset:2048 lds
.p2align 3
s_waitcnt vmcnt(10) lgkmcnt(0)
s_barrier
v_mfma_f32_32x32x16_bf16 v[0:15], v[96:99], v[144:147], 0
ds_read_b64_tr_b16 v[120:121], v208 offset:12288
ds_read_b64_tr_b16 v[122:123], v208 offset:13056
s_add_u32 m0, s70, 0
s_add_u32 s99, s99, 98304
s_cmp_eq_u32 s99, 1966080
s_cselect_b32 s99, 0, s99
buffer_load_dwordx4 v215, s[64:67], s99 offen offset:0 lds
v_mfma_f32_32x32x16_bf16 v[16:31], v[96:99], v[160:163], 0
ds_read_b64_tr_b16 v[128:129], v209 offset:12288
ds_read_b64_tr_b16 v[130:131], v209 offset:13056
v_mfma_f32_32x32x16_bf16 v[32:47], v[104:107], v[144:147], 0
ds_read_b64_tr_b16 v[136:137], v210 offset:12288
ds_read_b64_tr_b16 v[138:139], v210 offset:13056
buffer_load_dwordx4 v216, s[64:67], s99 offen offset:1024 lds
v_mfma_f32_32x32x16_bf16 v[48:63], v[104:107], v[160:163], 0
ds_read_b64_tr_b16 v[124:125], v208 offset:15360
ds_read_b64_tr_b16 v[126:127], v208 offset:16128
v_mfma_f32_32x32x16_bf16 v[64:79], v[112:115], v[144:147], 0
ds_read_b64_tr_b16 v[132:133], v209 offset:15360
ds_read_b64_tr_b16 v[134:135], v209 offset:16128
v_mfma_f32_32x32x16_bf16 v[80:95], v[112:115], v[160:163], 0
ds_read_b64_tr_b16 v[140:141], v210 offset:15360
ds_read_b64_tr_b16 v[142:143], v210 offset:16128
buffer_load_dwordx4 v217, s[64:67], s99 offen offset:2048 lds
v_mfma_f32_32x32x16_bf16 v[0:15], v[100:103], v[148:151], v[0:15]
v_mfma_f32_32x32x16_bf16 v[16:31], v[100:103], v[164:167], v[16:31]
s_add_u32 m0, s71, 0
s_add_u32 s100, s100, 128
s_cmp_eq_u32 s100, 1280
s_cselect_b32 s100, 0, s100
buffer_load_dwordx4 v218, s[60:63], s100 offen offset:0 lds
v_mfma_f32_32x32x16_bf16 v[32:47], v[108:111], v[148:151], v[32:47]
v_mfma_f32_32x32x16_bf16 v[48:63], v[108:111], v[164:167], v[48:63]
buffer_load_dwordx4 v219, s[60:63], s100 offen offset:1024 lds
v_mfma_f32_32x32x16_bf16 v[64:79], v[116:119], v[148:151], v[64:79]
v_mfma_f32_32x32x16_bf16 v[80:95], v[116:119], v[164:167], v[80:95]
s_waitcnt vmcnt(8) lgkmcnt(0)
s_barrier
v_mfma_f32_32x32x16_bf16 v[0:15], v[120:123], v[152:155], v[0:15]
ds_read_b128 v[176:179], v211 offset:16384
ds_read_b128 v[192:195], v211 offset:20480
s_add_u32 m0, s70, 12288
s_add_u32 s99, s99, 98304
buffer_load_dwordx4 v215, s[64:67], s99 offen offset:0 lds
v_mfma_f32_32x32x16_bf16 v[16:31], v[120:123], v[168:171], v[16:31]
ds_read_b64_tr_b16 v[96:97], v208 offset:24576
ds_read_b64_tr_b16 v[98:99], v208 offset:25344
v_mfma_f32_32x32x16_bf16 v[32:47], v[128:131], v[152:155], v[32:47]
ds_read_b64_tr_b16 v[104:105], v209 offset:24576
ds_read_b64_tr_b16 v[106:107], v209 offset:25344
buffer_load_dwordx4 v216, s[64:67], s99 offen offset:1024 lds
v_mfma_f32_32x32x16_bf16 v[48:63], v[128:131], v[168:171], v[48:63]
ds_read_b64_tr_b16 v[112:113], v210 offset:24576
ds_read_b64_tr_b16 v[114:115], v210 offset:25344
v_mfma_f32_32x32x16_bf16 v[64:79], v[136:139], v[152:155], v[64:79]
ds_read_b128 v[180:183], v212 offset:16384
ds_read_b128 v[196:199], v212 offset:20480
v_mfma_f32_32x32x16_bf16 v[80:95], v[136:139], v[168:171], v[80:95]
ds_read_b64_tr_b16 v[100:101], v208 offset:27648
ds_read_b64_tr_b16 v[102:103], v208 offset:28416
buffer_load_dwordx4 v217, s[64:67], s99 offen offset:2048 lds
v_mfma_f32_32x32x16_bf16 v[0:15], v[124:127], v[156:159], v[0:15]
ds_read_b64_tr_b16 v[108:109], v209 offset:27648
ds_read_b64_tr_b16 v[110:111], v209 offset:28416
v_mfma_f32_32x32x16_bf16 v[16:31], v[124:127], v[172:175], v[16:31]
ds_read_b64_tr_b16 v[116:117], v210 offset:27648
ds_read_b64_tr_b16 v[118:119], v210 offset:28416
s_add_u32 m0, s71, 0
s_nop 0
buffer_load_dwordx4 v220, s[60:63], s100 offen offset:2048 lds
v_mfma_f32_32x32x16_bf16 v[32:47], v[132:135], v[156:159], v[32:47]
ds_read_b128 v[184:187], v213 offset:16384
ds_read_b128 v[200:203], v213 offset:20480
v_mfma_f32_32x32x16_bf16 v[48:63], v[132:135], v[172:175], v[48:63]
ds_read_b128 v[188:191], v214 offset:16384
ds_read_b128 v[204:207], v214 offset:20480
buffer_load_dwordx4 v221, s[60:63], s100 offen offset:3072 lds
v_mfma_f32_32x32x16_bf16 v[64:79], v[140:143], v[156:159], v[64:79]
v_mfma_f32_32x32x16_bf16 v[80:95], v[140:143], v[172:175], v[80:95]
s_waitcnt vmcnt(10) lgkmcnt(0)
s_barrier
v_mfma_f32_32x32x16_bf16 v[0:15], v[96:99], v[176:179], v[0:15]
ds_read_b64_tr_b16 v[120:121], v208 offset:36864
ds_read_b64_tr_b16 v[122:123], v208 offset:37632
s_add_u32 m0, s70, 24576
s_add_u32 s99, s99, 98304
s_cmp_eq_u32 s99, 1966080
s_cselect_b32 s99, 0, s99
buffer_load_dwordx4 v215, s[64:67], s99 offen offset:0 lds
v_mfma_f32_32x32x16_bf16 v[16:31], v[96:99], v[192:195], v[16:31]
ds_read_b64_tr_b16 v[128:129], v209 offset:36864
ds_read_b64_tr_b16 v[130:131], v209 offset:37632
v_mfma_f32_32x32x16_bf16 v[32:47], v[104:107], v[176:179], v[32:47]
ds_read_b64_tr_b16 v[136:137], v210 offset:36864
ds_read_b64_tr_b16 v[138:139], v210 offset:37632
buffer_load_dwordx4 v216, s[64:67], s99 offen offset:1024 lds
v_mfma_f32_32x32x16_bf16 v[48:63], v[104:107], v[192:195], v[48:63]
ds_read_b64_tr_b16 v[124:125], v208 offset:39936
ds_read_b64_tr_b16 v[126:127], v208 offset:40704
v_mfma_f32_32x32x16_bf16 v[64:79], v[112:115], v[176:179], v[64:79]
ds_read_b64_tr_b16 v[132:133], v209 offset:39936
ds_read_b64_tr_b16 v[134:135], v209 offset:40704
v_mfma_f32_32x32x16_bf16 v[80:95], v[112:115], v[192:195], v[80:95]
ds_read_b64_tr_b16 v[140:141], v210 offset:39936
ds_read_b64_tr_b16 v[142:143], v210 offset:40704
buffer_load_dwordx4 v217, s[64:67], s99 offen offset:2048 lds
v_mfma_f32_32x32x16_bf16 v[0:15], v[100:103], v[180:183], v[0:15]
v_mfma_f32_32x32x16_bf16 v[16:31], v[100:103], v[196:199], v[16:31]
s_add_u32 m0, s71, 16384
s_add_u32 s100, s100, 128
s_cmp_eq_u32 s100, 1280
s_cselect_b32 s100, 0, s100
buffer_load_dwordx4 v218, s[60:63], s100 offen offset:0 lds
v_mfma_f32_32x32x16_bf16 v[32:47], v[108:111], v[180:183], v[32:47]
v_mfma_f32_32x32x16_bf16 v[48:63], v[108:111], v[196:199], v[48:63]
buffer_load_dwordx4 v219, s[60:63], s100 offen offset:1024 lds
v_mfma_f32_32x32x16_bf16 v[64:79], v[116:119], v[180:183], v[64:79]
v_mfma_f32_32x32x16_bf16 v[80:95], v[116:119], v[196:199], v[80:95]
s_waitcnt vmcnt(5) lgkmcnt(0)
s_barrier
v_mfma_f32_32x32x16_bf16 v[0:15], v[120:123], v[184:187], v[0:15]
ds_read_b128 v[144:147], v211 offset:0
ds_read_b128 v[160:163], v211 offset:4096
s_add_u32 m0, s70, 36864
s_add_u32 s99, s99, 98304
buffer_load_dwordx4 v215, s[64:67], s99 offen offset:0 lds
v_mfma_f32_32x32x16_bf16 v[16:31], v[120:123], v[200:203], v[16:31]
ds_read_b64_tr_b16 v[96:97], v208 offset:0
ds_read_b64_tr_b16 v[98:99], v208 offset:768
v_mfma_f32_32x32x16_bf16 v[32:47], v[128:131], v[184:187], v[32:47]
ds_read_b64_tr_b16 v[104:105], v209 offset:0
ds_read_b64_tr_b16 v[106:107], v209 offset:768
buffer_load_dwordx4 v216, s[64:67], s99 offen offset:1024 lds
v_mfma_f32_32x32x16_bf16 v[48:63], v[128:131], v[200:203], v[48:63]
ds_read_b64_tr_b16 v[112:113], v210 offset:0
ds_read_b64_tr_b16 v[114:115], v210 offset:768
v_mfma_f32_32x32x16_bf16 v[64:79], v[136:139], v[184:187], v[64:79]
ds_read_b128 v[148:151], v212 offset:0
ds_read_b128 v[164:167], v212 offset:4096
v_mfma_f32_32x32x16_bf16 v[80:95], v[136:139], v[200:203], v[80:95]
ds_read_b64_tr_b16 v[100:101], v208 offset:3072
ds_read_b64_tr_b16 v[102:103], v208 offset:3840
buffer_load_dwordx4 v217, s[64:67], s99 offen offset:2048 lds
v_mfma_f32_32x32x16_bf16 v[0:15], v[124:127], v[188:191], v[0:15]
ds_read_b64_tr_b16 v[108:109], v209 offset:3072
ds_read_b64_tr_b16 v[110:111], v209 offset:3840
v_mfma_f32_32x32x16_bf16 v[16:31], v[124:127], v[204:207], v[16:31]
ds_read_b64_tr_b16 v[116:117], v210 offset:3072
ds_read_b64_tr_b16 v[118:119], v210 offset:3840
s_add_u32 m0, s71, 16384
s_nop 0
buffer_load_dwordx4 v220, s[60:63], s100 offen offset:2048 lds
v_mfma_f32_32x32x16_bf16 v[32:47], v[132:135], v[188:191], v[32:47]
ds_read_b128 v[152:155], v213 offset:0
ds_read_b128 v[168:171], v213 offset:4096
v_mfma_f32_32x32x16_bf16 v[48:63], v[132:135], v[204:207], v[48:63]
ds_read_b128 v[156:159], v214 offset:0
ds_read_b128 v[172:175], v214 offset:4096
buffer_load_dwordx4 v221, s[60:63], s100 offen offset:3072 lds
v_mfma_f32_32x32x16_bf16 v[64:79], v[140:143], v[188:191], v[64:79]
v_mfma_f32_32x32x16_bf16 v[80:95], v[140:143], v[204:207], v[80:95]
s_waitcnt lgkmcnt(0)
s_barrier
v_mfma_f32_32x32x16_bf16 v[0:15], v[96:99], v[144:147], v[0:15]
ds_read_b64_tr_b16 v[120:121], v208 offset:12288
ds_read_b64_tr_b16 v[122:123], v208 offset:13056
s_add_u32 m0, s70, 0
s_add_u32 s99, s99, 98304
s_cmp_eq_u32 s99, 1966080
s_cselect_b32 s99, 0, s99
buffer_load_dwordx4 v215, s[64:67], s99 offen offset:0 lds
v_mfma_f32_32x32x16_bf16 v[16:31], v[96:99], v[160:163], v[16:31]
ds_read_b64_tr_b16 v[128:129], v209 offset:12288
ds_read_b64_tr_b16 v[130:131], v209 offset:13056
v_mfma_f32_32x32x16_bf16 v[32:47], v[104:107], v[144:147], v[32:47]
ds_read_b64_tr_b16 v[136:137], v210 offset:12288
ds_read_b64_tr_b16 v[138:139], v210 offset:13056
buffer_load_dwordx4 v216, s[64:67], s99 offen offset:1024 lds
v_mfma_f32_32x32x16_bf16 v[48:63], v[104:107], v[160:163], v[48:63]
ds_read_b64_tr_b16 v[124:125], v208 offset:15360
ds_read_b64_tr_b16 v[126:127], v208 offset:16128
v_mfma_f32_32x32x16_bf16 v[64:79], v[112:115], v[144:147], v[64:79]
ds_read_b64_tr_b16 v[132:133], v209 offset:15360
ds_read_b64_tr_b16 v[134:135], v209 offset:16128
v_mfma_f32_32x32x16_bf16 v[80:95], v[112:115], v[160:163], v[80:95]
ds_read_b64_tr_b16 v[140:141], v210 offset:15360
ds_read_b64_tr_b16 v[142:143], v210 offset:16128
buffer_load_dwordx4 v217, s[64:67], s99 offen offset:2048 lds
v_mfma_f32_32x32x16_bf16 v[0:15], v[100:103], v[148:151], v[0:15]
v_mfma_f32_32x32x16_bf16 v[16:31], v[100:103], v[164:167], v[16:31]
s_add_u32 m0, s71, 0
s_add_u32 s100, s100, 128
s_cmp_eq_u32 s100, 1280
s_cselect_b32 s100, 0, s100
buffer_load_dwordx4 v218, s[60:63], s100 offen offset:0 lds
v_mfma_f32_32x32x16_bf16 v[32:47], v[108:111], v[148:151], v[32:47]
v_mfma_f32_32x32x16_bf16 v[48:63], v[108:111], v[164:167], v[48:63]
buffer_load_dwordx4 v219, s[60:63], s100 offen offset:1024 lds
v_mfma_f32_32x32x16_bf16 v[64:79], v[116:119], v[148:151], v[64:79]
v_mfma_f32_32x32x16_bf16 v[80:95], v[116:119], v[164:167], v[80:95]
s_waitcnt vmcnt(5) lgkmcnt(0)
s_barrier
v_mfma_f32_32x32x16_bf16 v[0:15], v[120:123], v[152:155], v[0:15]
ds_read_b128 v[176:179], v211 offset:16384
ds_read_b128 v[192:195], v211 offset:20480
s_add_u32 m0, s70, 12288
s_add_u32 s99, s99, 98304
buffer_load_dwordx4 v215, s[64:67], s99 offen offset:0 lds
v_mfma_f32_32x32x16_bf16 v[16:31], v[120:123], v[168:171], v[16:31]
ds_read_b64_tr_b16 v[96:97], v208 offset:24576
ds_read_b64_tr_b16 v[98:99], v208 offset:25344
v_mfma_f32_32x32x16_bf16 v[32:47], v[128:131], v[152:155], v[32:47]
ds_read_b64_tr_b16 v[104:105], v209 offset:24576
ds_read_b64_tr_b16 v[106:107], v209 offset:25344
buffer_load_dwordx4 v216, s[64:67], s99 offen offset:1024 lds
v_mfma_f32_32x32x16_bf16 v[48:63], v[128:131], v[168:171], v[48:63]
ds_read_b64_tr_b16 v[112:113], v210 offset:24576
ds_read_b64_tr_b16 v[114:115], v210 offset:25344
v_mfma_f32_32x32x16_bf16 v[64:79], v[136:139], v[152:155], v[64:79]
ds_read_b128 v[180:183], v212 offset:16384
ds_read_b128 v[196:199], v212 offset:20480
v_mfma_f32_32x32x16_bf16 v[80:95], v[136:139], v[168:171], v[80:95]
ds_read_b64_tr_b16 v[100:101], v208 offset:27648
ds_read_b64_tr_b16 v[102:103], v208 offset:28416
buffer_load_dwordx4 v217, s[64:67], s99 offen offset:2048 lds
v_mfma_f32_32x32x16_bf16 v[0:15], v[124:127], v[156:159], v[0:15]
ds_read_b64_tr_b16 v[108:109], v209 offset:27648
ds_read_b64_tr_b16 v[110:111], v209 offset:28416
v_mfma_f32_32x32x16_bf16 v[16:31], v[124:127], v[172:175], v[16:31]
ds_read_b64_tr_b16 v[116:117], v210 offset:27648
ds_read_b64_tr_b16 v[118:119], v210 offset:28416
s_add_u32 m0, s71, 0
s_nop 0
buffer_load_dwordx4 v220, s[60:63], s100 offen offset:2048 lds
v_mfma_f32_32x32x16_bf16 v[32:47], v[132:135], v[156:159], v[32:47]
ds_read_b128 v[184:187], v213 offset:16384
ds_read_b128 v[200:203], v213 offset:20480
v_mfma_f32_32x32x16_bf16 v[48:63], v[132:135], v[172:175], v[48:63]
ds_read_b128 v[188:191], v214 offset:16384
ds_read_b128 v[204:207], v214 offset:20480
buffer_load_dwordx4 v221, s[60:63], s100 offen offset:3072 lds
v_mfma_f32_32x32x16_bf16 v[64:79], v[140:143], v[156:159], v[64:79]
v_mfma_f32_32x32x16_bf16 v[80:95], v[140:143], v[172:175], v[80:95]
s_waitcnt lgkmcnt(0)
s_barrier
v_mfma_f32_32x32x16_bf16 v[0:15], v[96:99], v[176:179], v[0:15]
ds_read_b64_tr_b16 v[120:121], v208 offset:36864
ds_read_b64_tr_b16 v[122:123], v208 offset:37632
s_add_u32 m0, s70, 24576
s_add_u32 s99, s99, 98304
s_cmp_eq_u32 s99, 1966080
s_cselect_b32 s99, 0, s99
buffer_load_dwordx4 v215, s[64:67], s99 offen offset:0 lds
v_mfma_f32_32x32x16_bf16 v[16:31], v[96:99], v[192:195], v[16:31]
ds_read_b64_tr_b16 v[128:129], v209 offset:36864
ds_read_b64_tr_b16 v[130:131], v209 offset:37632
v_mfma_f32_32x32x16_bf16 v[32:47], v[104:107], v[176:179], v[32:47]
ds_read_b64_tr_b16 v[136:137], v210 offset:36864
ds_read_b64_tr_b16 v[138:139], v210 offset:37632
buffer_load_dwordx4 v216, s[64:67], s99 offen offset:1024 lds
v_mfma_f32_32x32x16_bf16 v[48:63], v[104:107], v[192:195], v[48:63]
ds_read_b64_tr_b16 v[124:125], v208 offset:39936
ds_read_b64_tr_b16 v[126:127], v208 offset:40704
v_mfma_f32_32x32x16_bf16 v[64:79], v[112:115], v[176:179], v[64:79]
ds_read_b64_tr_b16 v[132:133], v209 offset:39936
ds_read_b64_tr_b16 v[134:135], v209 offset:40704
v_mfma_f32_32x32x16_bf16 v[80:95], v[112:115], v[192:195], v[80:95]
ds_read_b64_tr_b16 v[140:141], v210 offset:39936
ds_read_b64_tr_b16 v[142:143], v210 offset:40704
buffer_load_dwordx4 v217, s[64:67], s99 offen offset:2048 lds
v_mfma_f32_32x32x16_bf16 v[0:15], v[100:103], v[180:183], v[0:15]
v_mfma_f32_32x32x16_bf16 v[16:31], v[100:103], v[196:199], v[16:31]
s_add_u32 m0, s71, 16384
s_add_u32 s100, s100, 128
s_cmp_eq_u32 s100, 1280
s_cselect_b32 s100, 0, s100
buffer_load_dwordx4 v218, s[60:63], s100 offen offset:0 lds
v_mfma_f32_32x32x16_bf16 v[32:47], v[108:111], v[180:183], v[32:47]
v_mfma_f32_32x32x16_bf16 v[48:63], v[108:111], v[196:199], v[48:63]
buffer_load_dwordx4 v219, s[60:63], s100 offen offset:1024 lds
v_mfma_f32_32x32x16_bf16 v[64:79], v[116:119], v[180:183], v[64:79]
v_mfma_f32_32x32x16_bf16 v[80:95], v[116:119], v[196:199], v[80:95]
s_waitcnt vmcnt(5) lgkmcnt(0)
s_barrier
v_mfma_f32_32x32x16_bf16 v[0:15], v[120:123], v[184:187], v[0:15]
ds_read_b128 v[144:147], v211 offset:0
ds_read_b128 v[160:163], v211 offset:4096
s_add_u32 m0, s70, 36864
s_add_u32 s99, s99, 98304
buffer_load_dwordx4 v215, s[64:67], s99 offen offset:0 lds
v_mfma_f32_32x32x16_bf16 v[16:31], v[120:123], v[200:203], v[16:31]
ds_read_b64_tr_b16 v[96:97], v208 offset:0
ds_read_b64_tr_b16 v[98:99], v208 offset:768
v_mfma_f32_32x32x16_bf16 v[32:47], v[128:131], v[184:187], v[32:47]
ds_read_b64_tr_b16 v[104:105], v209 offset:0
ds_read_b64_tr_b16 v[106:107], v209 offset:768
buffer_load_dwordx4 v216, s[64:67], s99 offen offset:1024 lds
v_mfma_f32_32x32x16_bf16 v[48:63], v[128:131], v[200:203], v[48:63]
ds_read_b64_tr_b16 v[112:113], v210 offset:0
ds_read_b64_tr_b16 v[114:115], v210 offset:768
v_mfma_f32_32x32x16_bf16 v[64:79], v[136:139], v[184:187], v[64:79]
ds_read_b128 v[148:151], v212 offset:0
ds_read_b128 v[164:167], v212 offset:4096
v_mfma_f32_32x32x16_bf16 v[80:95], v[136:139], v[200:203], v[80:95]
ds_read_b64_tr_b16 v[100:101], v208 offset:3072
ds_read_b64_tr_b16 v[102:103], v208 offset:3840
buffer_load_dwordx4 v217, s[64:67], s99 offen offset:2048 lds
v_mfma_f32_32x32x16_bf16 v[0:15], v[124:127], v[188:191], v[0:15]
ds_read_b64_tr_b16 v[108:109], v209 offset:3072
ds_read_b64_tr_b16 v[110:111], v209 offset:3840
v_mfma_f32_32x32x16_bf16 v[16:31], v[124:127], v[204:207], v[16:31]
ds_read_b64_tr_b16 v[116:117], v210 offset:3072
ds_read_b64_tr_b16 v[118:119], v210 offset:3840
s_add_u32 m0, s71, 16384
s_nop 0
buffer_load_dwordx4 v220, s[60:63], s100 offen offset:2048 lds
v_mfma_f32_32x32x16_bf16 v[32:47], v[132:135], v[188:191], v[32:47]
ds_read_b128 v[152:155], v213 offset:0
ds_read_b128 v[168:171], v213 offset:4096
v_mfma_f32_32x32x16_bf16 v[48:63], v[132:135], v[204:207], v[48:63]
ds_read_b128 v[156:159], v214 offset:0
ds_read_b128 v[172:175], v214 offset:4096
buffer_load_dwordx4 v221, s[60:63], s100 offen offset:3072 lds
v_mfma_f32_32x32x16_bf16 v[64:79], v[140:143], v[188:191], v[64:79]
v_mfma_f32_32x32x16_bf16 v[80:95], v[140:143], v[204:207], v[80:95]
s_waitcnt lgkmcnt(0)
s_barrier
v_mfma_f32_32x32x16_bf16 v[0:15], v[96:99], v[144:147], v[0:15]
ds_read_b64_tr_b16 v[120:121], v208 offset:12288
ds_read_b64_tr_b16 v[122:123], v208 offset:13056
s_add_u32 m0, s70, 0
s_add_u32 s99, s99, 98304
s_cmp_eq_u32 s99, 1966080
s_cselect_b32 s99, 0, s99
buffer_load_dwordx4 v215, s[64:67], s99 offen offset:0 lds
v_mfma_f32_32x32x16_bf16 v[16:31], v[96:99], v[160:163], v[16:31]
ds_read_b64_tr_b16 v[128:129], v209 offset:12288
ds_read_b64_tr_b16 v[130:131], v209 offset:13056
v_mfma_f32_32x32x16_bf16 v[32:47], v[104:107], v[144:147], v[32:47]
ds_read_b64_tr_b16 v[136:137], v210 offset:12288
ds_read_b64_tr_b16 v[138:139], v210 offset:13056
buffer_load_dwordx4 v216, s[64:67], s99 offen offset:1024 lds
v_mfma_f32_32x32x16_bf16 v[48:63], v[104:107], v[160:163], v[48:63]
ds_read_b64_tr_b16 v[124:125], v208 offset:15360
ds_read_b64_tr_b16 v[126:127], v208 offset:16128
v_mfma_f32_32x32x16_bf16 v[64:79], v[112:115], v[144:147], v[64:79]
ds_read_b64_tr_b16 v[132:133], v209 offset:15360
ds_read_b64_tr_b16 v[134:135], v209 offset:16128
v_mfma_f32_32x32x16_bf16 v[80:95], v[112:115], v[160:163], v[80:95]
ds_read_b64_tr_b16 v[140:141], v210 offset:15360
ds_read_b64_tr_b16 v[142:143], v210 offset:16128
buffer_load_dwordx4 v217, s[64:67], s99 offen offset:2048 lds
v_mfma_f32_32x32x16_bf16 v[0:15], v[100:103], v[148:151], v[0:15]
v_mfma_f32_32x32x16_bf16 v[16:31], v[100:103], v[164:167], v[16:31]
s_add_u32 m0, s71, 0
s_add_u32 s100, s100, 128
s_cmp_eq_u32 s100, 1280
s_cselect_b32 s100, 0, s100
buffer_load_dwordx4 v218, s[60:63], s100 offen offset:0 lds
v_mfma_f32_32x32x16_bf16 v[32:47], v[108:111], v[148:151], v[32:47]
v_mfma_f32_32x32x16_bf16 v[48:63], v[108:111], v[164:167], v[48:63]
buffer_load_dwordx4 v219, s[60:63], s100 offen offset:1024 lds
v_mfma_f32_32x32x16_bf16 v[64:79], v[116:119], v[148:151], v[64:79]
v_mfma_f32_32x32x16_bf16 v[80:95], v[116:119], v[164:167], v[80:95]
s_mov_b64 exec, 1
buffer_load_dword v223, off, s[56:59], 0 sc1
s_mov_b64 exec, -1
s_waitcnt vmcnt(6) lgkmcnt(0)
s_barrier
v_mfma_f32_32x32x16_bf16 v[0:15], v[120:123], v[152:155], v[0:15]
ds_read_b128 v[176:179], v211 offset:16384
ds_read_b128 v[192:195], v211 offset:20480
s_add_u32 m0, s70, 12288
s_add_u32 s99, s99, 98304
buffer_load_dwordx4 v215, s[64:67], s99 offen offset:0 lds
v_mfma_f32_32x32x16_bf16 v[16:31], v[120:123], v[168:171], v[16:31]
ds_read_b64_tr_b16 v[96:97], v208 offset:24576
ds_read_b64_tr_b16 v[98:99], v208 offset:25344
v_mfma_f32_32x32x16_bf16 v[32:47], v[128:131], v[152:155], v[32:47]
ds_read_b64_tr_b16 v[104:105], v209 offset:24576
ds_read_b64_tr_b16 v[106:107], v209 offset:25344
buffer_load_dwordx4 v216, s[64:67], s99 offen offset:1024 lds
v_mfma_f32_32x32x16_bf16 v[48:63], v[128:131], v[168:171], v[48:63]
ds_read_b64_tr_b16 v[112:113], v210 offset:24576
ds_read_b64_tr_b16 v[114:115], v210 offset:25344
v_mfma_f32_32x32x16_bf16 v[64:79], v[136:139], v[152:155], v[64:79]
ds_read_b128 v[180:183], v212 offset:16384
ds_read_b128 v[196:199], v212 offset:20480
v_mfma_f32_32x32x16_bf16 v[80:95], v[136:139], v[168:171], v[80:95]
ds_read_b64_tr_b16 v[100:101], v208 offset:27648
ds_read_b64_tr_b16 v[102:103], v208 offset:28416
buffer_load_dwordx4 v217, s[64:67], s99 offen offset:2048 lds
v_mfma_f32_32x32x16_bf16 v[0:15], v[124:127], v[156:159], v[0:15]
ds_read_b64_tr_b16 v[108:109], v209 offset:27648
ds_read_b64_tr_b16 v[110:111], v209 offset:28416
v_mfma_f32_32x32x16_bf16 v[16:31], v[124:127], v[172:175], v[16:31]
ds_read_b64_tr_b16 v[116:117], v210 offset:27648
ds_read_b64_tr_b16 v[118:119], v210 offset:28416
s_add_u32 m0, s71, 0
s_nop 0
buffer_load_dwordx4 v220, s[60:63], s100 offen offset:2048 lds
v_mfma_f32_32x32x16_bf16 v[32:47], v[132:135], v[156:159], v[32:47]
ds_read_b128 v[184:187], v213 offset:16384
ds_read_b128 v[200:203], v213 offset:20480
v_mfma_f32_32x32x16_bf16 v[48:63], v[132:135], v[172:175], v[48:63]
ds_read_b128 v[188:191], v214 offset:16384
ds_read_b128 v[204:207], v214 offset:20480
buffer_load_dwordx4 v221, s[60:63], s100 offen offset:3072 lds
v_mfma_f32_32x32x16_bf16 v[64:79], v[140:143], v[156:159], v[64:79]
v_mfma_f32_32x32x16_bf16 v[80:95], v[140:143], v[172:175], v[80:95]
s_waitcnt lgkmcnt(0)
s_barrier
s_setprio 3
v_mfma_f32_32x32x16_bf16 v[0:15], v[96:99], v[176:179], v[0:15]
ds_read_b64_tr_b16 v[120:121], v208 offset:36864
ds_read_b64_tr_b16 v[122:123], v208 offset:37632
s_add_u32 m0, s70, 24576
s_add_u32 s99, s99, 98304
s_cmp_eq_u32 s99, 1966080
s_cselect_b32 s99, 0, s99
buffer_load_dwordx4 v215, s[64:67], s99 offen offset:0 lds
v_mfma_f32_32x32x16_bf16 v[16:31], v[96:99], v[192:195], v[16:31]
ds_read_b64_tr_b16 v[128:129], v209 offset:36864
ds_read_b64_tr_b16 v[130:131], v209 offset:37632
v_mfma_f32_32x32x16_bf16 v[32:47], v[104:107], v[176:179], v[32:47]
ds_read_b64_tr_b16 v[136:137], v210 offset:36864
ds_read_b64_tr_b16 v[138:139], v210 offset:37632
buffer_load_dwordx4 v216, s[64:67], s99 offen offset:1024 lds
v_mfma_f32_32x32x16_bf16 v[48:63], v[104:107], v[192:195], v[48:63]
ds_read_b64_tr_b16 v[124:125], v208 offset:39936
ds_read_b64_tr_b16 v[126:127], v208 offset:40704
v_mfma_f32_32x32x16_bf16 v[64:79], v[112:115], v[176:179], v[64:79]
ds_read_b64_tr_b16 v[132:133], v209 offset:39936
ds_read_b64_tr_b16 v[134:135], v209 offset:40704
v_mfma_f32_32x32x16_bf16 v[80:95], v[112:115], v[192:195], v[80:95]
ds_read_b64_tr_b16 v[140:141], v210 offset:39936
ds_read_b64_tr_b16 v[142:143], v210 offset:40704
buffer_load_dwordx4 v217, s[64:67], s99 offen offset:2048 lds
v_mfma_f32_32x32x16_bf16 v[0:15], v[100:103], v[180:183], v[0:15]
v_mfma_f32_32x32x16_bf16 v[16:31], v[100:103], v[196:199], v[16:31]
s_add_u32 m0, s71, 16384
s_add_u32 s100, s100, 128
s_cmp_eq_u32 s100, 1280
s_cselect_b32 s100, 0, s100
buffer_load_dwordx4 v218, s[60:63], s100 offen offset:0 lds
v_mfma_f32_32x32x16_bf16 v[32:47], v[108:111], v[180:183], v[32:47]
v_mfma_f32_32x32x16_bf16 v[48:63], v[108:111], v[196:199], v[48:63]
buffer_load_dwordx4 v219, s[60:63], s100 offen offset:1024 lds
v_mfma_f32_32x32x16_bf16 v[64:79], v[116:119], v[180:183], v[64:79]
v_mfma_f32_32x32x16_bf16 v[80:95], v[116:119], v[196:199], v[80:95]
s_waitcnt vmcnt(5) lgkmcnt(0)
s_cmp_lg_u32 s5, 0
s_cbranch_scc1 L_F_i
s_bfm_b64 exec, 1, 0
s_mov_b32 s8, 0
L_F_I_l:
v_cmp_eq_u32 vcc, 0, v223
s_add_u32 s8, s8, 1
s_cbranch_vccz L_F_I_d
s_cmp_ge_u32 s8, 200000
s_cbranch_scc1 L_F_I_d
buffer_load_dword v223, off, s[56:59], 0 sc1
s_waitcnt vmcnt(0)
s_branch L_F_I_l
L_F_I_d:
s_mov_b64 exec, -1
L_F_i:
.p2align 3
s_nop 0
s_barrier
v_mfma_f32_32x32x16_bf16 v[0:15], v[120:123], v[184:187], v[0:15]
ds_read_b128 v[144:147], v211 offset:0
ds_read_b128 v[160:163], v211 offset:4096
s_add_u32 m0, s70, 36864
s_add_u32 s99, s99, 98304
buffer_load_dwordx4 v215, s[64:67], s99 offen offset:0 lds
v_mfma_f32_32x32x16_bf16 v[16:31], v[120:123], v[200:203], v[16:31]
ds_read_b64_tr_b16 v[96:97], v208 offset:0
ds_read_b64_tr_b16 v[98:99], v208 offset:768
v_mfma_f32_32x32x16_bf16 v[32:47], v[128:131], v[184:187], v[32:47]
ds_read_b64_tr_b16 v[104:105], v209 offset:0
ds_read_b64_tr_b16 v[106:107], v209 offset:768
buffer_load_dwordx4 v216, s[64:67], s99 offen offset:1024 lds
v_mfma_f32_32x32x16_bf16 v[48:63], v[128:131], v[200:203], v[48:63]
ds_read_b64_tr_b16 v[112:113], v210 offset:0
ds_read_b64_tr_b16 v[114:115], v210 offset:768
v_mfma_f32_32x32x16_bf16 v[64:79], v[136:139], v[184:187], v[64:79]
ds_read_b128 v[148:151], v212 offset:0
ds_read_b128 v[164:167], v212 offset:4096
v_mfma_f32_32x32x16_bf16 v[80:95], v[136:139], v[200:203], v[80:95]
ds_read_b64_tr_b16 v[100:101], v208 offset:3072
ds_read_b64_tr_b16 v[102:103], v208 offset:3840
buffer_load_dwordx4 v217, s[64:67], s99 offen offset:2048 lds
v_mfma_f32_32x32x16_bf16 v[0:15], v[124:127], v[188:191], v[0:15]
ds_read_b64_tr_b16 v[108:109], v209 offset:3072
ds_read_b64_tr_b16 v[110:111], v209 offset:3840
v_mfma_f32_32x32x16_bf16 v[16:31], v[124:127], v[204:207], v[16:31]
ds_read_b64_tr_b16 v[116:117], v210 offset:3072
ds_read_b64_tr_b16 v[118:119], v210 offset:3840
s_add_u32 m0, s71, 16384
s_nop 0
buffer_load_dwordx4 v220, s[60:63], s100 offen offset:2048 lds
v_mfma_f32_32x32x16_bf16 v[32:47], v[132:135], v[188:191], v[32:47]
ds_read_b128 v[152:155], v213 offset:0
ds_read_b128 v[168:171], v213 offset:4096
v_mfma_f32_32x32x16_bf16 v[48:63], v[132:135], v[204:207], v[48:63]
ds_read_b128 v[156:159], v214 offset:0
ds_read_b128 v[172:175], v214 offset:4096
buffer_load_dwordx4 v221, s[60:63], s100 offen offset:3072 lds
v_mfma_f32_32x32x16_bf16 v[64:79], v[140:143], v[188:191], v[64:79]
v_mfma_f32_32x32x16_bf16 v[80:95], v[140:143], v[204:207], v[80:95]
s_waitcnt lgkmcnt(0)
s_barrier
v_mfma_f32_32x32x16_bf16 v[0:15], v[96:99], v[144:147], v[0:15]
ds_read_b64_tr_b16 v[120:121], v208 offset:12288
ds_read_b64_tr_b16 v[122:123], v208 offset:13056
s_add_u32 m0, s70, 0
s_add_u32 s99, s99, 98304
s_cmp_eq_u32 s99, 1966080
s_cselect_b32 s99, 0, s99
buffer_load_dwordx4 v215, s[64:67], s99 offen offset:0 lds
v_mfma_f32_32x32x16_bf16 v[16:31], v[96:99], v[160:163], v[16:31]
ds_read_b64_tr_b16 v[128:129], v209 offset:12288
ds_read_b64_tr_b16 v[130:131], v209 offset:13056
v_mfma_f32_32x32x16_bf16 v[32:47], v[104:107], v[144:147], v[32:47]
ds_read_b64_tr_b16 v[136:137], v210 offset:12288
ds_read_b64_tr_b16 v[138:139], v210 offset:13056
buffer_load_dwordx4 v216, s[64:67], s99 offen offset:1024 lds
v_mfma_f32_32x32x16_bf16 v[48:63], v[104:107], v[160:163], v[48:63]
ds_read_b64_tr_b16 v[124:125], v208 offset:15360
ds_read_b64_tr_b16 v[126:127], v208 offset:16128
v_mfma_f32_32x32x16_bf16 v[64:79], v[112:115], v[144:147], v[64:79]
ds_read_b64_tr_b16 v[132:133], v209 offset:15360
ds_read_b64_tr_b16 v[134:135], v209 offset:16128
v_mfma_f32_32x32x16_bf16 v[80:95], v[112:115], v[160:163], v[80:95]
ds_read_b64_tr_b16 v[140:141], v210 offset:15360
ds_read_b64_tr_b16 v[142:143], v210 offset:16128
buffer_load_dwordx4 v217, s[64:67], s99 offen offset:2048 lds
v_mfma_f32_32x32x16_bf16 v[0:15], v[100:103], v[148:151], v[0:15]
v_mfma_f32_32x32x16_bf16 v[16:31], v[100:103], v[164:167], v[16:31]
s_add_u32 m0, s71, 0
s_add_u32 s100, s100, 128
s_cmp_eq_u32 s100, 1280
s_cselect_b32 s100, 0, s100
buffer_load_dwordx4 v218, s[60:63], s100 offen offset:0 lds
v_mfma_f32_32x32x16_bf16 v[32:47], v[108:111], v[148:151], v[32:47]
v_mfma_f32_32x32x16_bf16 v[48:63], v[108:111], v[164:167], v[48:63]
buffer_load_dwordx4 v219, s[60:63], s100 offen offset:1024 lds
v_mfma_f32_32x32x16_bf16 v[64:79], v[116:119], v[148:151], v[64:79]
v_mfma_f32_32x32x16_bf16 v[80:95], v[116:119], v[164:167], v[80:95]
s_mov_b32 exec_hi, 0
buffer_load_dword v223, v253, s[52:55], s98 offen sc1
s_mov_b64 exec, -1
s_waitcnt vmcnt(6) lgkmcnt(0)
s_barrier
v_mfma_f32_32x32x16_bf16 v[0:15], v[120:123], v[152:155], v[0:15]
ds_read_b128 v[176:179], v211 offset:16384
ds_read_b128 v[192:195], v211 offset:20480
s_add_u32 m0, s70, 12288
s_add_u32 s99, s99, 98304
buffer_load_dwordx4 v215, s[64:67], s99 offen offset:0 lds
v_mfma_f32_32x32x16_bf16 v[16:31], v[120:123], v[168:171], v[16:31]
ds_read_b64_tr_b16 v[96:97], v208 offset:24576
ds_read_b64_tr_b16 v[98:99], v208 offset:25344
v_mfma_f32_32x32x16_bf16 v[32:47], v[128:131], v[152:155], v[32:47]
ds_read_b64_tr_b16 v[104:105], v209 offset:24576
ds_read_b64_tr_b16 v[106:107], v209 offset:25344
buffer_load_dwordx4 v216, s[64:67], s99 offen offset:1024 lds
v_mfma_f32_32x32x16_bf16 v[48:63], v[128:131], v[168:171], v[48:63]
ds_read_b64_tr_b16 v[112:113], v210 offset:24576
ds_read_b64_tr_b16 v[114:115], v210 offset:25344
v_mfma_f32_32x32x16_bf16 v[64:79], v[136:139], v[152:155], v[64:79]
ds_read_b128 v[180:183], v212 offset:16384
ds_read_b128 v[196:199], v212 offset:20480
v_mfma_f32_32x32x16_bf16 v[80:95], v[136:139], v[168:171], v[80:95]
ds_read_b64_tr_b16 v[100:101], v208 offset:27648
ds_read_b64_tr_b16 v[102:103], v208 offset:28416
buffer_load_dwordx4 v217, s[64:67], s99 offen offset:2048 lds
v_mfma_f32_32x32x16_bf16 v[0:15], v[124:127], v[156:159], v[0:15]
ds_read_b64_tr_b16 v[108:109], v209 offset:27648
ds_read_b64_tr_b16 v[110:111], v209 offset:28416
v_mfma_f32_32x32x16_bf16 v[16:31], v[124:127], v[172:175], v[16:31]
ds_read_b64_tr_b16 v[116:117], v210 offset:27648
ds_read_b64_tr_b16 v[118:119], v210 offset:28416
s_add_u32 m0, s71, 0
s_nop 0
buffer_load_dwordx4 v220, s[60:63], s100 offen offset:2048 lds
v_mfma_f32_32x32x16_bf16 v[32:47], v[132:135], v[156:159], v[32:47]
ds_read_b128 v[184:187], v213 offset:16384
ds_read_b128 v[200:203], v213 offset:20480
v_mfma_f32_32x32x16_bf16 v[48:63], v[132:135], v[172:175], v[48:63]
ds_read_b128 v[188:191], v214 offset:16384
ds_read_b128 v[204:207], v214 offset:20480
buffer_load_dwordx4 v221, s[60:63], s100 offen offset:3072 lds
v_mfma_f32_32x32x16_bf16 v[64:79], v[140:143], v[156:159], v[64:79]
v_mfma_f32_32x32x16_bf16 v[80:95], v[140:143], v[172:175], v[80:95]
s_waitcnt lgkmcnt(0)
s_barrier
v_mfma_f32_32x32x16_bf16 v[0:15], v[96:99], v[176:179], v[0:15]
ds_read_b64_tr_b16 v[120:121], v208 offset:36864
ds_read_b64_tr_b16 v[122:123], v208 offset:37632
s_add_u32 m0, s70, 24576
s_add_u32 s99, s99, 98304
s_cmp_eq_u32 s99, 1966080
s_cselect_b32 s99, 0, s99
buffer_load_dwordx4 v215, s[64:67], s99 offen offset:0 lds
v_mfma_f32_32x32x16_bf16 v[16:31], v[96:99], v[192:195], v[16:31]
ds_read_b64_tr_b16 v[128:129], v209 offset:36864
ds_read_b64_tr_b16 v[130:131], v209 offset:37632
v_mfma_f32_32x32x16_bf16 v[32:47], v[104:107], v[176:179], v[32:47]
ds_read_b64_tr_b16 v[136:137], v210 offset:36864
ds_read_b64_tr_b16 v[138:139], v210 offset:37632
buffer_load_dwordx4 v216, s[64:67], s99 offen offset:1024 lds
v_mfma_f32_32x32x16_bf16 v[48:63], v[104:107], v[192:195], v[48:63]
ds_read_b64_tr_b16 v[124:125], v208 offset:39936
ds_read_b64_tr_b16 v[126:127], v208 offset:40704
v_mfma_f32_32x32x16_bf16 v[64:79], v[112:115], v[176:179], v[64:79]
ds_read_b64_tr_b16 v[132:133], v209 offset:39936
ds_read_b64_tr_b16 v[134:135], v209 offset:40704
v_mfma_f32_32x32x16_bf16 v[80:95], v[112:115], v[192:195], v[80:95]
ds_read_b64_tr_b16 v[140:141], v210 offset:39936
ds_read_b64_tr_b16 v[142:143], v210 offset:40704
buffer_load_dwordx4 v217, s[64:67], s99 offen offset:2048 lds
v_mfma_f32_32x32x16_bf16 v[0:15], v[100:103], v[180:183], v[0:15]
v_mfma_f32_32x32x16_bf16 v[16:31], v[100:103], v[196:199], v[16:31]
s_add_u32 m0, s71, 16384
s_add_u32 s100, s100, 128
s_cmp_eq_u32 s100, 1280
s_cselect_b32 s100, 0, s100
buffer_load_dwordx4 v218, s[60:63], s100 offen offset:0 lds
v_mfma_f32_32x32x16_bf16 v[32:47], v[108:111], v[180:183], v[32:47]
v_mfma_f32_32x32x16_bf16 v[48:63], v[108:111], v[196:199], v[48:63]
buffer_load_dwordx4 v219, s[60:63], s100 offen offset:1024 lds
v_mfma_f32_32x32x16_bf16 v[64:79], v[116:119], v[180:183], v[64:79]
v_mfma_f32_32x32x16_bf16 v[80:95], v[116:119], v[196:199], v[80:95]
s_waitcnt vmcnt(5) lgkmcnt(0)
s_cmp_lg_u32 s5, 0
s_cbranch_scc1 L_F_p
s_bfm_b64 exec, 32, 0
s_mov_b32 s8, 0
L_F_W_l:
v_cmp_eq_u32 vcc, 0, v223
s_add_u32 s8, s8, 1
s_cbranch_vccz L_F_W_d
s_cmp_ge_u32 s8, 200000
s_cbranch_scc1 L_F_W_d
buffer_load_dword v223, v253, s[52:55], s98 offen sc1
s_waitcnt vmcnt(0)
s_branch L_F_W_l
L_F_W_d:
s_mov_b64 exec, -1
L_F_p:
.p2align 3
s_nop 0
s_barrier
v_mfma_f32_32x32x16_bf16 v[0:15], v[120:123], v[184:187], v[0:15]
ds_read_b128 v[144:147], v211 offset:0
ds_read_b128 v[160:163], v211 offset:4096
s_add_u32 m0, s70, 36864
s_add_u32 s99, s99, 98304
buffer_load_dwordx4 v215, s[64:67], s99 offen offset:0 lds
v_mfma_f32_32x32x16_bf16 v[16:31], v[120:123], v[200:203], v[16:31]
ds_read_b64_tr_b16 v[96:97], v208 offset:0
ds_read_b64_tr_b16 v[98:99], v208 offset:768
v_mfma_f32_32x32x16_bf16 v[32:47], v[128:131], v[184:187], v[32:47]
ds_read_b64_tr_b16 v[104:105], v209 offset:0
ds_read_b64_tr_b16 v[106:107], v209 offset:768
buffer_load_dwordx4 v216, s[64:67], s99 offen offset:1024 lds
v_mfma_f32_32x32x16_bf16 v[48:63], v[128:131], v[200:203], v[48:63]
ds_read_b64_tr_b16 v[112:113], v210 offset:0
ds_read_b64_tr_b16 v[114:115], v210 offset:768
v_mfma_f32_32x32x16_bf16 v[64:79], v[136:139], v[184:187], v[64:79]
ds_read_b128 v[148:151], v212 offset:0
ds_read_b128 v[164:167], v212 offset:4096
v_mfma_f32_32x32x16_bf16 v[80:95], v[136:139], v[200:203], v[80:95]
ds_read_b64_tr_b16 v[100:101], v208 offset:3072
ds_read_b64_tr_b16 v[102:103], v208 offset:3840
buffer_load_dwordx4 v217, s[64:67], s99 offen offset:2048 lds
v_mfma_f32_32x32x16_bf16 v[0:15], v[124:127], v[188:191], v[0:15]
ds_read_b64_tr_b16 v[108:109], v209 offset:3072
ds_read_b64_tr_b16 v[110:111], v209 offset:3840
v_mfma_f32_32x32x16_bf16 v[16:31], v[124:127], v[204:207], v[16:31]
ds_read_b64_tr_b16 v[116:117], v210 offset:3072
ds_read_b64_tr_b16 v[118:119], v210 offset:3840
s_add_u32 m0, s71, 16384
s_nop 0
buffer_load_dwordx4 v220, s[60:63], s100 offen offset:2048 lds
v_mfma_f32_32x32x16_bf16 v[32:47], v[132:135], v[188:191], v[32:47]
ds_read_b128 v[152:155], v213 offset:0
ds_read_b128 v[168:171], v213 offset:4096
v_mfma_f32_32x32x16_bf16 v[48:63], v[132:135], v[204:207], v[48:63]
ds_read_b128 v[156:159], v214 offset:0
ds_read_b128 v[172:175], v214 offset:4096
buffer_load_dwordx4 v221, s[60:63], s100 offen offset:3072 lds
v_mfma_f32_32x32x16_bf16 v[64:79], v[140:143], v[188:191], v[64:79]
v_mfma_f32_32x32x16_bf16 v[80:95], v[140:143], v[204:207], v[80:95]
s_waitcnt lgkmcnt(0)
s_barrier
v_mfma_f32_32x32x16_bf16 v[0:15], v[96:99], v[144:147], v[0:15]
ds_read_b64_tr_b16 v[120:121], v208 offset:12288
ds_read_b64_tr_b16 v[122:123], v208 offset:13056
s_add_u32 m0, s70, 0
s_mul_i32 s72, s23, 5
s_add_u32 s72, s72, s74
buffer_load_dwordx4 v244, s[52:55], s72 offen offset:0 sc1 lds
v_mfma_f32_32x32x16_bf16 v[16:31], v[96:99], v[160:163], v[16:31]
ds_read_b64_tr_b16 v[128:129], v209 offset:12288
ds_read_b64_tr_b16 v[130:131], v209 offset:13056
buffer_load_dwordx4 v244, s[52:55], s72 offen offset:1024 sc1 lds
v_mfma_f32_32x32x16_bf16 v[32:47], v[104:107], v[144:147], v[32:47]
ds_read_b64_tr_b16 v[136:137], v210 offset:12288
ds_read_b64_tr_b16 v[138:139], v210 offset:13056
v_mfma_f32_32x32x16_bf16 v[48:63], v[104:107], v[160:163], v[48:63]
ds_read_b64_tr_b16 v[124:125], v208 offset:15360
ds_read_b64_tr_b16 v[126:127], v208 offset:16128
buffer_load_dwordx4 v244, s[52:55], s72 offen offset:2048 sc1 lds
v_mfma_f32_32x32x16_bf16 v[64:79], v[112:115], v[144:147], v[64:79]
ds_read_b64_tr_b16 v[132:133], v209 offset:15360
ds_read_b64_tr_b16 v[134:135], v209 offset:16128
v_mfma_f32_32x32x16_bf16 v[80:95], v[112:115], v[160:163], v[80:95]
ds_read_b64_tr_b16 v[140:141], v210 offset:15360
ds_read_b64_tr_b16 v[142:143], v210 offset:16128
s_add_u32 m0, s71, 0
s_mul_i32 s72, s23, 5
s_add_u32 s72, s72, s74
s_add_i32 s72, s72, 3072
buffer_load_dwordx4 v244, s[52:55], s72 offen offset:0 sc1 lds
v_mfma_f32_32x32x16_bf16 v[0:15], v[100:103], v[148:151], v[0:15]
buffer_load_dwordx4 v244, s[52:55], s72 offen offset:1024 sc1 lds
v_mfma_f32_32x32x16_bf16 v[16:31], v[100:103], v[164:167], v[16:31]
v_mfma_f32_32x32x16_bf16 v[32:47], v[108:111], v[148:151], v[32:47]
s_mul_i32 s72, s24, 5
s_add_u32 s72, s72, s74
s_add_i32 s72, s72, -2048
buffer_load_dwordx4 v244, s[52:55], s72 offen offset:2048 sc1 lds
v_mfma_f32_32x32x16_bf16 v[48:63], v[108:111], v[164:167], v[48:63]
v_mfma_f32_32x32x16_bf16 v[64:79], v[116:119], v[148:151], v[64:79]
buffer_load_dwordx4 v244, s[52:55], s72 offen offset:3072 sc1 lds
v_mfma_f32_32x32x16_bf16 v[80:95], v[116:119], v[164:167], v[80:95]
s_waitcnt vmcnt(7) lgkmcnt(0)
s_barrier
v_mfma_f32_32x32x16_bf16 v[0:15], v[120:123], v[152:155], v[0:15]
ds_read_b128 v[176:179], v211 offset:16384
ds_read_b128 v[192:195], v211 offset:20480
s_add_u32 m0, s70, 12288
s_mul_i32 s72, s24, 5
s_add_u32 s72, s72, s74
s_add_i32 s72, s72, 2048
buffer_load_dwordx4 v244, s[52:55], s72 offen offset:0 sc1 lds
v_mfma_f32_32x32x16_bf16 v[16:31], v[120:123], v[168:171], v[16:31]
ds_read_b64_tr_b16 v[96:97], v208 offset:24576
ds_read_b64_tr_b16 v[98:99], v208 offset:25344
v_mfma_f32_32x32x16_bf16 v[32:47], v[128:131], v[152:155], v[32:47]
ds_read_b64_tr_b16 v[104:105], v209 offset:24576
ds_read_b64_tr_b16 v[106:107], v209 offset:25344
v_mfma_f32_32x32x16_bf16 v[48:63], v[128:131], v[168:171], v[48:63]
ds_read_b64_tr_b16 v[112:113], v210 offset:24576
ds_read_b64_tr_b16 v[114:115], v210 offset:25344
v_mfma_f32_32x32x16_bf16 v[64:79], v[136:139], v[152:155], v[64:79]
ds_read_b128 v[180:183], v212 offset:16384
ds_read_b128 v[196:199], v212 offset:20480
buffer_load_dwordx4 v244, s[52:55], s72 offen offset:1024 sc1 lds
v_mfma_f32_32x32x16_bf16 v[80:95], v[136:139], v[168:171], v[80:95]
ds_read_b64_tr_b16 v[100:101], v208 offset:27648
ds_read_b64_tr_b16 v[102:103], v208 offset:28416
v_mfma_f32_32x32x16_bf16 v[0:15], v[124:127], v[156:159], v[0:15]
ds_read_b64_tr_b16 v[108:109], v209 offset:27648
ds_read_b64_tr_b16 v[110:111], v209 offset:28416
v_mfma_f32_32x32x16_bf16 v[16:31], v[124:127], v[172:175], v[16:31]
ds_read_b64_tr_b16 v[116:117], v210 offset:27648
ds_read_b64_tr_b16 v[118:119], v210 offset:28416
v_mfma_f32_32x32x16_bf16 v[32:47], v[132:135], v[156:159], v[32:47]
ds_read_b128 v[184:187], v213 offset:16384
ds_read_b128 v[200:203], v213 offset:20480
buffer_load_dwordx4 v244, s[52:55], s72 offen offset:2048 sc1 lds
v_mfma_f32_32x32x16_bf16 v[48:63], v[132:135], v[172:175], v[48:63]
ds_read_b128 v[188:191], v214 offset:16384
ds_read_b128 v[204:207], v214 offset:20480
v_mfma_f32_32x32x16_bf16 v[64:79], v[140:143], v[156:159], v[64:79]
v_mfma_f32_32x32x16_bf16 v[80:95], v[140:143], v[172:175], v[80:95]
s_waitcnt lgkmcnt(0)
s_barrier
v_mfma_f32_32x32x16_bf16 v[0:15], v[96:99], v[176:179], v[0:15]
ds_read_b64_tr_b16 v[120:121], v208 offset:36864
ds_read_b64_tr_b16 v[122:123], v208 offset:37632
s_add_u32 m0, s70, 24576
s_mul_i32 s72, s25, 5
s_add_u32 s72, s72, s74
buffer_load_dwordx4 v244, s[52:55], s72 offen offset:0 sc1 lds
v_mfma_f32_32x32x16_bf16 v[16:31], v[96:99], v[192:195], v[16:31]
ds_read_b64_tr_b16 v[128:129], v209 offset:36864
ds_read_b64_tr_b16 v[130:131], v209 offset:37632
buffer_load_dwordx4 v244, s[52:55], s72 offen offset:1024 sc1 lds
v_mfma_f32_32x32x16_bf16 v[32:47], v[104:107], v[176:179], v[32:47]
ds_read_b64_tr_b16 v[136:137], v210 offset:36864
ds_read_b64_tr_b16 v[138:139], v210 offset:37632
v_mfma_f32_32x32x16_bf16 v[48:63], v[104:107], v[192:195], v[48:63]
ds_read_b64_tr_b16 v[124:125], v208 offset:39936
ds_read_b64_tr_b16 v[126:127], v208 offset:40704
buffer_load_dwordx4 v244, s[52:55], s72 offen offset:2048 sc1 lds
v_mfma_f32_32x32x16_bf16 v[64:79], v[112:115], v[176:179], v[64:79]
ds_read_b64_tr_b16 v[132:133], v209 offset:39936
ds_read_b64_tr_b16 v[134:135], v209 offset:40704
v_mfma_f32_32x32x16_bf16 v[80:95], v[112:115], v[192:195], v[80:95]
ds_read_b64_tr_b16 v[140:141], v210 offset:39936
ds_read_b64_tr_b16 v[142:143], v210 offset:40704
s_add_u32 m0, s71, 16384
s_mul_i32 s72, s25, 5
s_add_u32 s72, s72, s74
s_add_i32 s72, s72, 3072
buffer_load_dwordx4 v244, s[52:55], s72 offen offset:0 sc1 lds
v_mfma_f32_32x32x16_bf16 v[0:15], v[100:103], v[180:183], v[0:15]
buffer_load_dwordx4 v244, s[52:55], s72 offen offset:1024 sc1 lds
v_mfma_f32_32x32x16_bf16 v[16:31], v[100:103], v[196:199], v[16:31]
v_mfma_f32_32x32x16_bf16 v[32:47], v[108:111], v[180:183], v[32:47]
s_mul_i32 s72, s26, 5
s_add_u32 s72, s72, s74
s_add_i32 s72, s72, -2048
buffer_load_dwordx4 v244, s[52:55], s72 offen offset:2048 sc1 lds
v_mfma_f32_32x32x16_bf16 v[48:63], v[108:111], v[196:199], v[48:63]
v_mfma_f32_32x32x16_bf16 v[64:79], v[116:119], v[180:183], v[64:79]
buffer_load_dwordx4 v244, s[52:55], s72 offen offset:3072 sc1 lds
v_mfma_f32_32x32x16_bf16 v[80:95], v[116:119], v[196:199], v[80:95]
s_waitcnt lgkmcnt(0)
s_barrier
v_mfma_f32_32x32x16_bf16 v[0:15], v[120:123], v[184:187], v[0:15]
v_mfma_f32_32x32x16_bf16 v[16:31], v[120:123], v[200:203], v[16:31]
v_mfma_f32_32x32x16_bf16 v[32:47], v[128:131], v[184:187], v[32:47]
v_mfma_f32_32x32x16_bf16 v[48:63], v[128:131], v[200:203], v[48:63]
v_mfma_f32_32x32x16_bf16 v[64:79], v[136:139], v[184:187], v[64:79]
v_mfma_f32_32x32x16_bf16 v[80:95], v[136:139], v[200:203], v[80:95]
v_mfma_f32_32x32x16_bf16 v[0:15], v[124:127], v[188:191], v[0:15]
v_mfma_f32_32x32x16_bf16 v[16:31], v[124:127], v[204:207], v[16:31]
v_mfma_f32_32x32x16_bf16 v[32:47], v[132:135], v[188:191], v[32:47]
v_mfma_f32_32x32x16_bf16 v[48:63], v[132:135], v[204:207], v[48:63]
v_mfma_f32_32x32x16_bf16 v[64:79], v[140:143], v[188:191], v[64:79]
v_mfma_f32_32x32x16_bf16 v[80:95], v[140:143], v[204:207], v[80:95]
s_nop 6
v_mul_f32 v0, v0, v8
v_mul_f32 v1, v1, v9
v_mul_f32 v2, v2, v10
v_mul_f32 v3, v3, v11
v_mul_f32 v4, v4, v12
v_mul_f32 v5, v5, v13
v_mul_f32 v6, v6, v14
v_mul_f32 v7, v7, v15
v_cvt_pk_bf16_f32 v96, v0, v1
v_cvt_pk_bf16_f32 v97, v2, v3
v_cvt_pk_bf16_f32 v98, v4, v5
v_cvt_pk_bf16_f32 v99, v6, v7
buffer_store_dwordx4 v[96:99], v244, s[52:55], s50 offen offset:0 sc1
v_mul_f32 v16, v16, v24
v_mul_f32 v17, v17, v25
v_mul_f32 v18, v18, v26
v_mul_f32 v19, v19, v27
v_mul_f32 v20, v20, v28
v_mul_f32 v21, v21, v29
v_mul_f32 v22, v22, v30
v_mul_f32 v23, v23, v31
v_cvt_pk_bf16_f32 v100, v16, v17
v_cvt_pk_bf16_f32 v101, v18, v19
v_cvt_pk_bf16_f32 v102, v20, v21
v_cvt_pk_bf16_f32 v103, v22, v23
buffer_store_dwordx4 v[100:103], v244, s[52:55], s50 offen offset:1024 sc1
v_mul_f32 v32, v32, v40
v_mul_f32 v33, v33, v41
v_mul_f32 v34, v34, v42
v_mul_f32 v35, v35, v43
v_mul_f32 v36, v36, v44
v_mul_f32 v37, v37, v45
v_mul_f32 v38, v38, v46
v_mul_f32 v39, v39, v47
v_cvt_pk_bf16_f32 v104, v32, v33
v_cvt_pk_bf16_f32 v105, v34, v35
v_cvt_pk_bf16_f32 v106, v36, v37
v_cvt_pk_bf16_f32 v107, v38, v39
buffer_store_dwordx4 v[104:107], v244, s[52:55], s50 offen offset:2048 sc1
v_mul_f32 v48, v48, v56
v_mul_f32 v49, v49, v57
v_mul_f32 v50, v50, v58
v_mul_f32 v51, v51, v59
v_mul_f32 v52, v52, v60
v_mul_f32 v53, v53, v61
v_mul_f32 v54, v54, v62
v_mul_f32 v55, v55, v63
v_cvt_pk_bf16_f32 v108, v48, v49
v_cvt_pk_bf16_f32 v109, v50, v51
v_cvt_pk_bf16_f32 v110, v52, v53
v_cvt_pk_bf16_f32 v111, v54, v55
buffer_store_dwordx4 v[108:111], v244, s[52:55], s50 offen offset:3072 sc1
v_mul_f32 v64, v64, v72
v_mul_f32 v65, v65, v73
v_mul_f32 v66, v66, v74
v_mul_f32 v67, v67, v75
v_mul_f32 v68, v68, v76
v_mul_f32 v69, v69, v77
v_mul_f32 v70, v70, v78
v_mul_f32 v71, v71, v79
v_cvt_pk_bf16_f32 v112, v64, v65
v_cvt_pk_bf16_f32 v113, v66, v67
v_cvt_pk_bf16_f32 v114, v68, v69
v_cvt_pk_bf16_f32 v115, v70, v71
buffer_store_dwordx4 v[112:115], v244, s[52:55], s51 offen offset:0 sc1
v_mul_f32 v80, v80, v88
v_mul_f32 v81, v81, v89
v_mul_f32 v82, v82, v90
v_mul_f32 v83, v83, v91
v_mul_f32 v84, v84, v92
v_mul_f32 v85, v85, v93
v_mul_f32 v86, v86, v94
v_mul_f32 v87, v87, v95
v_cvt_pk_bf16_f32 v116, v80, v81
v_cvt_pk_bf16_f32 v117, v82, v83
v_cvt_pk_bf16_f32 v118, v84, v85
v_cvt_pk_bf16_f32 v119, v86, v87
buffer_store_dwordx4 v[116:119], v244, s[52:55], s51 offen offset:1024 sc1
s_lshl_b32 s11, s11, 5
s_add_u32 s10, s10, s11
s_lshl_b32 s10, s10, 2
s_add_u32 s10, s10, 14745600
s_lshr_b32 s11, s68, 1
s_lshl_b32 s11, s11, 7
s_add_u32 s11, s11, 14745600
s_lshl_b32 s15, s3, 3
s_add_u32 s15, s15, s69
s_lshl_b32 s15, s15, 7
s_add_u32 s15, s15, 14747648
s_sub_u32 s72, s10, 14745600
s_and_b32 s73, s72, 63
s_lshr_b32 s72, s72, 7
s_lshl_b32 s72, s72, 6
s_add_u32 s72, s72, s73
s_lshl_b32 s72, s72, 5
s_add_u32 s10, s72, 14761984
s_sub_u32 s11, s11, 14745600
s_lshl_b32 s11, s11, 4
s_add_u32 s11, s11, 14761984
v_lshlrev_b32 v254, 7, v251
s_waitcnt vmcnt(0)
s_barrier
s_cmp_lg_u32 s5, 0
s_cbranch_scc1 L_F_s
s_bfm_b64 exec, 1, 0
v_mov_b32 v2, 1
buffer_store_dword v2, v253, s[52:55], s10 offen sc1
s_mov_b64 exec, -1
L_F_s:
s_add_u32 m0, s70, 36864
s_mul_i32 s72, s26, 5
s_add_u32 s72, s72, s74
s_add_i32 s72, s72, 2048
buffer_load_dwordx4 v244, s[52:55], s72 offen offset:0 sc1 lds
buffer_load_dwordx4 v244, s[52:55], s72 offen offset:1024 sc1 lds
buffer_load_dwordx4 v244, s[52:55], s72 offen offset:2048 sc1 lds
s_setprio 1
s_lshl_b32 s8, s5, 9
s_add_u32 s11, s11, s8
s_mul_i32 s72, s18, 5
s_add_u32 s72, s72, s74
buffer_load_dwordx4 v[80:83], v244, s[52:55], s72 offen offset:0 sc1
buffer_load_dwordx4 v[84:87], v244, s[52:55], s72 offen offset:1024 sc1
buffer_load_dwordx4 v[88:91], v244, s[52:55], s72 offen offset:2048 sc1
buffer_load_dwordx4 v[92:95], v244, s[52:55], s72 offen offset:3072 sc1
s_mul_i32 s72, s18, 5
s_add_u32 s72, s72, s74
s_add_u32 s72, s72, 4096
buffer_load_dwordx4 v[96:99], v244, s[52:55], s72 offen offset:0 sc1
s_mul_i32 s72, s19, 5
s_add_u32 s72, s72, s74
buffer_load_dwordx4 v[100:103], v244, s[52:55], s72 offen offset:0 sc1
buffer_load_dwordx4 v[104:107], v244, s[52:55], s72 offen offset:1024 sc1
buffer_load_dwordx4 v[108:111], v244, s[52:55], s72 offen offset:2048 sc1
buffer_load_dwordx4 v[112:115], v244, s[52:55], s72 offen offset:3072 sc1
s_mul_i32 s72, s19, 5
s_add_u32 s72, s72, s74
s_add_u32 s72, s72, 4096
buffer_load_dwordx4 v[116:119], v244, s[52:55], s72 offen offset:0 sc1
s_mul_i32 s72, s20, 5
s_add_u32 s72, s72, s74
buffer_load_dwordx4 v[120:123], v244, s[52:55], s72 offen offset:0 sc1
buffer_load_dwordx4 v[124:127], v244, s[52:55], s72 offen offset:1024 sc1
buffer_load_dwordx4 v[128:131], v244, s[52:55], s72 offen offset:2048 sc1
buffer_load_dwordx4 v[132:135], v244, s[52:55], s72 offen offset:3072 sc1
s_mul_i32 s72, s20, 5
s_add_u32 s72, s72, s74
s_add_u32 s72, s72, 4096
buffer_load_dwordx4 v[136:139], v244, s[52:55], s72 offen offset:0 sc1
s_mul_i32 s72, s21, 5
s_add_u32 s72, s72, s74
buffer_load_dwordx4 v[140:143], v244, s[52:55], s72 offen offset:0 sc1
buffer_load_dwordx4 v[144:147], v244, s[52:55], s72 offen offset:1024 sc1
buffer_load_dwordx4 v[148:151], v244, s[52:55], s72 offen offset:2048 sc1
buffer_load_dwordx4 v[152:155], v244, s[52:55], s72 offen offset:3072 sc1
s_mul_i32 s72, s21, 5
s_add_u32 s72, s72, s74
s_add_u32 s72, s72, 4096
buffer_load_dwordx4 v[156:159], v244, s[52:55], s72 offen offset:0 sc1
s_mul_i32 s72, s22, 5
s_add_u32 s72, s72, s74
buffer_load_dwordx4 v[160:163], v244, s[52:55], s72 offen offset:0 sc1
buffer_load_dwordx4 v[164:167], v244, s[52:55], s72 offen offset:1024 sc1
buffer_load_dwordx4 v[168:171], v244, s[52:55], s72 offen offset:2048 sc1
buffer_load_dwordx4 v[172:175], v244, s[52:55], s72 offen offset:3072 sc1
s_mul_i32 s72, s22, 5
s_add_u32 s72, s72, s74
s_add_u32 s72, s72, 4096
buffer_load_dwordx4 v[176:179], v244, s[52:55], s72 offen offset:0 sc1
s_mov_b64 exec, 15
v_mov_b32 v2, 0
s_mov_b32 s8, 0
L_F_H_l:
v_cmp_eq_u32 vcc, 0, v2
s_add_u32 s8, s8, 1
s_cbranch_vccz L_F_H_d
s_cmp_ge_u32 s8, 200000
s_cbranch_scc1 L_F_H_d
buffer_load_dword v2, v254, s[52:55], s11 offen sc1
s_waitcnt vmcnt(0)
s_branch L_F_H_l
L_F_H_d:
s_mov_b64 exec, -1
s_lshl2_add_u32 s14, s18, s75
buffer_load_dwordx4 v[68:71], v245, s[52:55], s14 offen sc1
buffer_load_dwordx4 v[72:75], v246, s[52:55], s14 offen sc1
buffer_load_dwordx4 v[76:79], v247, s[52:55], s14 offen sc1
buffer_load_dwordx4 v[196:199], v248, s[52:55], s14 offen sc1
s_lshl2_add_u32 s14, s19, s75
buffer_load_dwordx4 v[200:203], v245, s[52:55], s14 offen sc1
buffer_load_dwordx4 v[204:207], v246, s[52:55], s14 offen sc1
buffer_load_dwordx4 v[208:211], v247, s[52:55], s14 offen sc1
buffer_load_dwordx4 v[212:215], v248, s[52:55], s14 offen sc1
s_lshl2_add_u32 s14, s20, s75
buffer_load_dwordx4 v[180:183], v245, s[52:55], s14 offen sc1
buffer_load_dwordx4 v[184:187], v246, s[52:55], s14 offen sc1
buffer_load_dwordx4 v[188:191], v247, s[52:55], s14 offen sc1
buffer_load_dwordx4 v[192:195], v248, s[52:55], s14 offen sc1
s_lshl2_add_u32 s14, s21, s75
buffer_load_dwordx4 v[216:219], v245, s[52:55], s14 offen sc1
buffer_load_dwordx4 v[220:223], v246, s[52:55], s14 offen sc1
buffer_load_dwordx4 v[224:227], v247, s[52:55], s14 offen sc1
buffer_load_dwordx4 v[228:231], v248, s[52:55], s14 offen sc1
s_lshl2_add_u32 s14, s22, s75
buffer_load_dwordx4 v[232:235], v245, s[52:55], s14 offen sc1
buffer_load_dwordx4 v[236:239], v246, s[52:55], s14 offen sc1
buffer_load_dwordx4 v[240:243], v247, s[52:55], s14 offen sc1
.p2align 3
s_waitcnt vmcnt(18)
v_mfma_f32_16x16x32_bf16 v[0:3], v[80:83], v[68:71], 0
v_mfma_f32_16x16x32_bf16 v[16:19], v[84:87], v[68:71], 0
v_mfma_f32_16x16x32_bf16 v[32:35], v[88:91], v[68:71], 0
v_mfma_f32_16x16x32_bf16 v[48:51], v[92:95], v[68:71], 0
v_mfma_f32_16x16x32_bf16 v[64:67], v[96:99], v[68:71], 0
s_waitcnt vmcnt(17)
v_mfma_f32_16x16x32_bf16 v[4:7], v[80:83], v[72:75], 0
v_mfma_f32_16x16x32_bf16 v[20:23], v[84:87], v[72:75], 0
v_mfma_f32_16x16x32_bf16 v[36:39], v[88:91], v[72:75], 0
v_mfma_f32_16x16x32_bf16 v[52:55], v[92:95], v[72:75], 0
v_mfma_f32_16x16x32_bf16 v[68:71], v[96:99], v[72:75], 0
s_waitcnt vmcnt(16)
v_mfma_f32_16x16x32_bf16 v[8:11], v[80:83], v[76:79], 0
v_mfma_f32_16x16x32_bf16 v[24:27], v[84:87], v[76:79], 0
v_mfma_f32_16x16x32_bf16 v[40:43], v[88:91], v[76:79], 0
v_mfma_f32_16x16x32_bf16 v[56:59], v[92:95], v[76:79], 0
v_mfma_f32_16x16x32_bf16 v[72:75], v[96:99], v[76:79], 0
s_waitcnt vmcnt(15)
v_mfma_f32_16x16x32_bf16 v[12:15], v[80:83], v[196:199], 0
v_mfma_f32_16x16x32_bf16 v[28:31], v[84:87], v[196:199], 0
v_mfma_f32_16x16x32_bf16 v[44:47], v[88:91], v[196:199], 0
v_mfma_f32_16x16x32_bf16 v[60:63], v[92:95], v[196:199], 0
v_mfma_f32_16x16x32_bf16 v[76:79], v[96:99], v[196:199], 0
ds_read_b128 v[80:83], v249 offset:0
ds_read_b128 v[84:87], v249 offset:1024
ds_read_b128 v[88:91], v249 offset:2048
ds_read_b128 v[92:95], v250 offset:0
ds_read_b128 v[96:99], v250 offset:1024
s_waitcnt vmcnt(14)
v_mfma_f32_16x16x32_bf16 v[0:3], v[100:103], v[200:203], v[0:3]
buffer_load_dwordx4 v[196:199], v248, s[52:55], s14 offen sc1
v_mfma_f32_16x16x32_bf16 v[16:19], v[104:107], v[200:203], v[16:19]
v_mfma_f32_16x16x32_bf16 v[32:35], v[108:111], v[200:203], v[32:35]
v_mfma_f32_16x16x32_bf16 v[48:51], v[112:115], v[200:203], v[48:51]
v_mfma_f32_16x16x32_bf16 v[64:67], v[116:119], v[200:203], v[64:67]
s_waitcnt vmcnt(14)
v_mfma_f32_16x16x32_bf16 v[4:7], v[100:103], v[204:207], v[4:7]
s_waitcnt lgkmcnt(0)
s_lshl2_add_u32 s14, s23, s75
buffer_load_dwordx4 v[200:203], v245, s[52:55], s14 offen sc1
v_mfma_f32_16x16x32_bf16 v[20:23], v[104:107], v[204:207], v[20:23]
v_mfma_f32_16x16x32_bf16 v[36:39], v[108:111], v[204:207], v[36:39]
v_mfma_f32_16x16x32_bf16 v[52:55], v[112:115], v[204:207], v[52:55]
s_add_u32 m0, s70, 0
s_mul_i32 s73, s27, 5
s_add_u32 s73, s73, s74
buffer_load_dwordx4 v244, s[52:55], s73 offen offset:0 sc1 lds
v_mfma_f32_16x16x32_bf16 v[68:71], v[116:119], v[204:207], v[68:71]
s_waitcnt vmcnt(15)
v_mfma_f32_16x16x32_bf16 v[8:11], v[100:103], v[208:211], v[8:11]
v_mfma_f32_16x16x32_bf16 v[24:27], v[104:107], v[208:211], v[24:27]
buffer_load_dwordx4 v[204:207], v246, s[52:55], s14 offen sc1
v_mfma_f32_16x16x32_bf16 v[40:43], v[108:111], v[208:211], v[40:43]
v_mfma_f32_16x16x32_bf16 v[56:59], v[112:115], v[208:211], v[56:59]
v_mfma_f32_16x16x32_bf16 v[72:75], v[116:119], v[208:211], v[72:75]
buffer_load_dwordx4 v244, s[52:55], s73 offen offset:1024 sc1 lds
s_waitcnt vmcnt(16)
v_mfma_f32_16x16x32_bf16 v[12:15], v[100:103], v[212:215], v[12:15]
v_mfma_f32_16x16x32_bf16 v[28:31], v[104:107], v[212:215], v[28:31]
v_mfma_f32_16x16x32_bf16 v[44:47], v[108:111], v[212:215], v[44:47]
buffer_load_dwordx4 v[208:211], v247, s[52:55], s14 offen sc1
v_mfma_f32_16x16x32_bf16 v[60:63], v[112:115], v[212:215], v[60:63]
v_mfma_f32_16x16x32_bf16 v[76:79], v[116:119], v[212:215], v[76:79]
s_waitcnt vmcnt(16)
v_mfma_f32_16x16x32_bf16 v[0:3], v[120:123], v[180:183], v[0:3]
buffer_load_dwordx4 v[100:103], v248, s[52:55], s14 offen sc1
v_mfma_f32_16x16x32_bf16 v[16:19], v[124:127], v[180:183], v[16:19]
v_mfma_f32_16x16x32_bf16 v[32:35], v[128:131], v[180:183], v[32:35]
v_mfma_f32_16x16x32_bf16 v[48:51], v[132:135], v[180:183], v[48:51]
s_lshl2_add_u32 s14, s24, s75
buffer_load_dwordx4 v[104:107], v245, s[52:55], s14 offen sc1
v_mfma_f32_16x16x32_bf16 v[64:67], v[136:139], v[180:183], v[64:67]
s_waitcnt vmcnt(17)
v_mfma_f32_16x16x32_bf16 v[4:7], v[120:123], v[184:187], v[4:7]
v_mfma_f32_16x16x32_bf16 v[20:23], v[124:127], v[184:187], v[20:23]
buffer_load_dwordx4 v[108:111], v246, s[52:55], s14 offen sc1
v_mfma_f32_16x16x32_bf16 v[36:39], v[128:131], v[184:187], v[36:39]
v_mfma_f32_16x16x32_bf16 v[52:55], v[132:135], v[184:187], v[52:55]
v_mfma_f32_16x16x32_bf16 v[68:71], v[136:139], v[184:187], v[68:71]
buffer_load_dwordx4 v[112:115], v247, s[52:55], s14 offen sc1
s_waitcnt vmcnt(18)
v_mfma_f32_16x16x32_bf16 v[8:11], v[120:123], v[188:191], v[8:11]
v_mfma_f32_16x16x32_bf16 v[24:27], v[124:127], v[188:191], v[24:27]
v_mfma_f32_16x16x32_bf16 v[40:43], v[128:131], v[188:191], v[40:43]
buffer_load_dwordx4 v[212:215], v248, s[52:55], s14 offen sc1
v_mfma_f32_16x16x32_bf16 v[56:59], v[132:135], v[188:191], v[56:59]
v_mfma_f32_16x16x32_bf16 v[72:75], v[136:139], v[188:191], v[72:75]
s_waitcnt vmcnt(18)
v_mfma_f32_16x16x32_bf16 v[12:15], v[120:123], v[192:195], v[12:15]
s_lshl2_add_u32 s14, s25, s75
buffer_load_dwordx4 v[180:183], v245, s[52:55], s14 offen sc1
v_mfma_f32_16x16x32_bf16 v[28:31], v[124:127], v[192:195], v[28:31]
v_mfma_f32_16x16x32_bf16 v[44:47], v[128:131], v[192:195], v[44:47]
v_mfma_f32_16x16x32_bf16 v[60:63], v[132:135], v[192:195], v[60:63]
buffer_load_dwordx4 v[184:187], v246, s[52:55], s14 offen sc1
v_mfma_f32_16x16x32_bf16 v[76:79], v[136:139], v[192:195], v[76:79]
s_waitcnt vmcnt(19)
v_mfma_f32_16x16x32_bf16 v[0:3], v[140:143], v[216:219], v[0:3]
v_mfma_f32_16x16x32_bf16 v[16:19], v[144:147], v[216:219], v[16:19]
buffer_load_dwordx4 v[188:191], v247, s[52:55], s14 offen sc1
v_mfma_f32_16x16x32_bf16 v[32:35], v[148:151], v[216:219], v[32:35]
v_mfma_f32_16x16x32_bf16 v[48:51], v[152:155], v[216:219], v[48:51]
v_mfma_f32_16x16x32_bf16 v[64:67], v[156:159], v[216:219], v[64:67]
buffer_load_dwordx4 v[192:195], v248, s[52:55], s14 offen sc1
s_waitcnt vmcnt(20)
v_mfma_f32_16x16x32_bf16 v[4:7], v[140:143], v[220:223], v[4:7]
v_mfma_f32_16x16x32_bf16 v[20:23], v[144:147], v[220:223], v[20:23]
v_mfma_f32_16x16x32_bf16 v[36:39], v[148:151], v[220:223], v[36:39]
buffer_load_dwordx4 v244, s[52:55], s73 offen offset:2048 sc1 lds
v_mfma_f32_16x16x32_bf16 v[52:55], v[152:155], v[220:223], v[52:55]
v_mfma_f32_16x16x32_bf16 v[68:71], v[156:159], v[220:223], v[68:71]
s_waitcnt vmcnt(20)
v_mfma_f32_16x16x32_bf16 v[8:11], v[140:143], v[224:227], v[8:11]
s_add_u32 m0, s71, 0
s_mul_i32 s73, s27, 5
s_add_u32 s73, s73, s74
s_add_u32 s73, s73, 3072
buffer_load_dwordx4 v244, s[52:55], s73 offen offset:0 sc1 lds
v_mfma_f32_16x16x32_bf16 v[24:27], v[144:147], v[224:227], v[24:27]
v_mfma_f32_16x16x32_bf16 v[40:43], v[148:151], v[224:227], v[40:43]
v_mfma_f32_16x16x32_bf16 v[56:59], v[152:155], v[224:227], v[56:59]
buffer_load_dwordx4 v244, s[52:55], s73 offen offset:1024 sc1 lds
v_mfma_f32_16x16x32_bf16 v[72:75], v[156:159], v[224:227], v[72:75]
s_waitcnt vmcnt(21)
v_mfma_f32_16x16x32_bf16 v[12:15], v[140:143], v[228:231], v[12:15]
v_mfma_f32_16x16x32_bf16 v[28:31], v[144:147], v[228:231], v[28:31]
s_lshl2_add_u32 s14, s26, s75
buffer_load_dwordx4 v[116:119], v245, s[52:55], s14 offen sc1
v_mfma_f32_16x16x32_bf16 v[44:47], v[148:151], v[228:231], v[44:47]
v_mfma_f32_16x16x32_bf16 v[60:63], v[152:155], v[228:231], v[60:63]
v_mfma_f32_16x16x32_bf16 v[76:79], v[156:159], v[228:231], v[76:79]
buffer_load_dwordx4 v[120:123], v246, s[52:55], s14 offen sc1
s_waitcnt vmcnt(22)
v_mfma_f32_16x16x32_bf16 v[0:3], v[160:163], v[232:235], v[0:3]
v_mfma_f32_16x16x32_bf16 v[16:19], v[164:167], v[232:235], v[16:19]
v_mfma_f32_16x16x32_bf16 v[32:35], v[168:171], v[232:235], v[32:35]
buffer_load_dwordx4 v[124:127], v247, s[52:55], s14 offen sc1
v_mfma_f32_16x16x32_bf16 v[48:51], v[172:175], v[232:235], v[48:51]
v_mfma_f32_16x16x32_bf16 v[64:67], v[176:179], v[232:235], v[64:67]
s_waitcnt vmcnt(22)
v_mfma_f32_16x16x32_bf16 v[4:7], v[160:163], v[236:239], v[4:7]
buffer_load_dwordx4 v[128:131], v248, s[52:55], s14 offen sc1
v_mfma_f32_16x16x32_bf16 v[20:23], v[164:167], v[236:239], v[20:23]
v_mfma_f32_16x16x32_bf16 v[36:39], v[168:171], v[236:239], v[36:39]
v_mfma_f32_16x16x32_bf16 v[52:55], v[172:175], v[236:239], v[52:55]
s_lshl2_add_u32 s14, s27, s75
buffer_load_dwordx4 v[132:135], v245, s[52:55], s14 offen sc1
v_mfma_f32_16x16x32_bf16 v[68:71], v[176:179], v[236:239], v[68:71]
s_waitcnt vmcnt(23)
v_mfma_f32_16x16x32_bf16 v[8:11], v[160:163], v[240:243], v[8:11]
v_mfma_f32_16x16x32_bf16 v[24:27], v[164:167], v[240:243], v[24:27]
buffer_load_dwordx4 v[136:139], v246, s[52:55], s14 offen sc1
v_mfma_f32_16x16x32_bf16 v[40:43], v[168:171], v[240:243], v[40:43]
v_mfma_f32_16x16x32_bf16 v[56:59], v[172:175], v[240:243], v[56:59]
v_mfma_f32_16x16x32_bf16 v[72:75], v[176:179], v[240:243], v[72:75]
buffer_load_dwordx4 v[216:219], v247, s[52:55], s14 offen sc1
s_waitcnt vmcnt(24)
v_mfma_f32_16x16x32_bf16 v[12:15], v[160:163], v[196:199], v[12:15]
v_mfma_f32_16x16x32_bf16 v[28:31], v[164:167], v[196:199], v[28:31]
v_mfma_f32_16x16x32_bf16 v[44:47], v[168:171], v[196:199], v[44:47]
buffer_load_dwordx4 v[220:223], v248, s[52:55], s14 offen sc1
v_mfma_f32_16x16x32_bf16 v[60:63], v[172:175], v[196:199], v[60:63]
v_mfma_f32_16x16x32_bf16 v[76:79], v[176:179], v[196:199], v[76:79]
ds_read_b128 v[160:163], v250 offset:2048
ds_read_b128 v[164:167], v250 offset:3072
ds_read_b128 v[168:171], v249 offset:12288
ds_read_b128 v[172:175], v249 offset:13312
ds_read_b128 v[176:179], v249 offset:14336
s_waitcnt vmcnt(24)
v_mfma_f32_16x16x32_bf16 v[0:3], v[80:83], v[200:203], v[0:3]
s_mul_i32 s72, s28, 5
s_add_u32 s72, s72, s74
buffer_load_dwordx4 v[224:227], v244, s[52:55], s72 offen offset:0 sc1
v_mfma_f32_16x16x32_bf16 v[16:19], v[84:87], v[200:203], v[16:19]
v_mfma_f32_16x16x32_bf16 v[32:35], v[88:91], v[200:203], v[32:35]
v_mfma_f32_16x16x32_bf16 v[48:51], v[92:95], v[200:203], v[48:51]
buffer_load_dwordx4 v[140:143], v244, s[52:55], s72 offen offset:1024 sc1
v_mfma_f32_16x16x32_bf16 v[64:67], v[96:99], v[200:203], v[64:67]
s_waitcnt vmcnt(24)
v_mfma_f32_16x16x32_bf16 v[4:7], v[80:83], v[204:207], v[4:7]
v_mfma_f32_16x16x32_bf16 v[20:23], v[84:87], v[204:207], v[20:23]
buffer_load_dwordx4 v[144:147], v244, s[52:55], s72 offen offset:2048 sc1
v_mfma_f32_16x16x32_bf16 v[36:39], v[88:91], v[204:207], v[36:39]
v_mfma_f32_16x16x32_bf16 v[52:55], v[92:95], v[204:207], v[52:55]
v_mfma_f32_16x16x32_bf16 v[68:71], v[96:99], v[204:207], v[68:71]
buffer_load_dwordx4 v[148:151], v244, s[52:55], s72 offen offset:3072 sc1
s_waitcnt vmcnt(24)
v_mfma_f32_16x16x32_bf16 v[8:11], v[80:83], v[208:211], v[8:11]
v_mfma_f32_16x16x32_bf16 v[24:27], v[84:87], v[208:211], v[24:27]
v_mfma_f32_16x16x32_bf16 v[40:43], v[88:91], v[208:211], v[40:43]
s_mul_i32 s72, s28, 5
s_add_u32 s72, s72, s74
s_add_u32 s72, s72, 4096
buffer_load_dwordx4 v[152:155], v244, s[52:55], s72 offen offset:0 sc1
v_mfma_f32_16x16x32_bf16 v[56:59], v[92:95], v[208:211], v[56:59]
v_mfma_f32_16x16x32_bf16 v[72:75], v[96:99], v[208:211], v[72:75]
s_waitcnt vmcnt(24)
v_mfma_f32_16x16x32_bf16 v[12:15], v[80:83], v[100:103], v[12:15]
s_lshl2_add_u32 s14, s28, s75
buffer_load_dwordx4 v[228:231], v246, s[52:55], s14 offen sc1
v_mfma_f32_16x16x32_bf16 v[28:31], v[84:87], v[100:103], v[28:31]
v_mfma_f32_16x16x32_bf16 v[44:47], v[88:91], v[100:103], v[44:47]
v_mfma_f32_16x16x32_bf16 v[60:63], v[92:95], v[100:103], v[60:63]
s_mul_i32 s72, s29, 5
s_add_u32 s72, s72, s74
buffer_load_dwordx4 v[156:159], v244, s[52:55], s72 offen offset:0 sc1
v_mfma_f32_16x16x32_bf16 v[76:79], v[96:99], v[100:103], v[76:79]
ds_read_b128 v[80:83], v249 offset:24576
ds_read_b128 v[84:87], v249 offset:25600
ds_read_b128 v[88:91], v249 offset:26624
ds_read_b128 v[92:95], v250 offset:16384
ds_read_b128 v[96:99], v250 offset:17408
s_waitcnt vmcnt(25) lgkmcnt(5)
v_mfma_f32_16x16x32_bf16 v[0:3], v[160:163], v[104:107], v[0:3]
v_mfma_f32_16x16x32_bf16 v[16:19], v[164:167], v[104:107], v[16:19]
buffer_load_dwordx4 v[232:235], v244, s[52:55], s72 offen offset:1024 sc1
v_mfma_f32_16x16x32_bf16 v[32:35], v[168:171], v[104:107], v[32:35]
v_mfma_f32_16x16x32_bf16 v[48:51], v[172:175], v[104:107], v[48:51]
v_mfma_f32_16x16x32_bf16 v[64:67], v[176:179], v[104:107], v[64:67]
buffer_load_dwordx4 v[236:239], v244, s[52:55], s72 offen offset:2048 sc1
s_waitcnt vmcnt(26)
v_mfma_f32_16x16x32_bf16 v[4:7], v[160:163], v[108:111], v[4:7]
v_mfma_f32_16x16x32_bf16 v[20:23], v[164:167], v[108:111], v[20:23]
v_mfma_f32_16x16x32_bf16 v[36:39], v[168:171], v[108:111], v[36:39]
buffer_load_dwordx4 v[240:243], v244, s[52:55], s72 offen offset:3072 sc1
v_mfma_f32_16x16x32_bf16 v[52:55], v[172:175], v[108:111], v[52:55]
v_mfma_f32_16x16x32_bf16 v[68:71], v[176:179], v[108:111], v[68:71]
s_waitcnt vmcnt(26)
v_mfma_f32_16x16x32_bf16 v[8:11], v[160:163], v[112:115], v[8:11]
s_mul_i32 s72, s29, 5
s_add_u32 s72, s72, s74
s_add_u32 s72, s72, 4096
buffer_load_dwordx4 v[196:199], v244, s[52:55], s72 offen offset:0 sc1
v_mfma_f32_16x16x32_bf16 v[24:27], v[164:167], v[112:115], v[24:27]
v_mfma_f32_16x16x32_bf16 v[40:43], v[168:171], v[112:115], v[40:43]
v_mfma_f32_16x16x32_bf16 v[56:59], v[172:175], v[112:115], v[56:59]
s_lshl2_add_u32 s14, s29, s75
buffer_load_dwordx4 v[200:203], v246, s[52:55], s14 offen sc1
v_mfma_f32_16x16x32_bf16 v[72:75], v[176:179], v[112:115], v[72:75]
s_waitcnt vmcnt(27)
v_mfma_f32_16x16x32_bf16 v[12:15], v[160:163], v[212:215], v[12:15]
v_mfma_f32_16x16x32_bf16 v[28:31], v[164:167], v[212:215], v[28:31]
s_lshl2_add_u32 s14, s28, s75
buffer_load_dwordx4 v[204:207], v247, s[52:55], s14 offen sc1
v_mfma_f32_16x16x32_bf16 v[44:47], v[168:171], v[212:215], v[44:47]
v_mfma_f32_16x16x32_bf16 v[60:63], v[172:175], v[212:215], v[60:63]
v_mfma_f32_16x16x32_bf16 v[76:79], v[176:179], v[212:215], v[76:79]
s_lshl2_add_u32 s14, s29, s75
buffer_load_dwordx4 v[208:211], v247, s[52:55], s14 offen sc1
ds_read_b128 v[160:163], v250 offset:18432
ds_read_b128 v[164:167], v250 offset:19456
ds_read_b128 v[168:171], v249 offset:36864
ds_read_b128 v[172:175], v249 offset:37888
ds_read_b128 v[176:179], v249 offset:38912
s_waitcnt vmcnt(28) lgkmcnt(5)
v_mfma_f32_16x16x32_bf16 v[0:3], v[80:83], v[180:183], v[0:3]
v_mfma_f32_16x16x32_bf16 v[16:19], v[84:87], v[180:183], v[16:19]
v_mfma_f32_16x16x32_bf16 v[32:35], v[88:91], v[180:183], v[32:35]
s_lshl2_add_u32 s14, s28, s75
buffer_load_dwordx4 v[100:103], v248, s[52:55], s14 offen sc1
v_mfma_f32_16x16x32_bf16 v[48:51], v[92:95], v[180:183], v[48:51]
v_mfma_f32_16x16x32_bf16 v[64:67], v[96:99], v[180:183], v[64:67]
s_waitcnt vmcnt(28)
v_mfma_f32_16x16x32_bf16 v[4:7], v[80:83], v[184:187], v[4:7]
s_lshl2_add_u32 s14, s29, s75
buffer_load_dwordx4 v[104:107], v248, s[52:55], s14 offen sc1
v_mfma_f32_16x16x32_bf16 v[20:23], v[84:87], v[184:187], v[20:23]
v_mfma_f32_16x16x32_bf16 v[36:39], v[88:91], v[184:187], v[36:39]
v_mfma_f32_16x16x32_bf16 v[52:55], v[92:95], v[184:187], v[52:55]
s_lshl2_add_u32 s14, s28, s75
buffer_load_dwordx4 v[108:111], v245, s[52:55], s14 offen sc1
v_mfma_f32_16x16x32_bf16 v[68:71], v[96:99], v[184:187], v[68:71]
s_waitcnt vmcnt(29)
v_mfma_f32_16x16x32_bf16 v[8:11], v[80:83], v[188:191], v[8:11]
v_mfma_f32_16x16x32_bf16 v[24:27], v[84:87], v[188:191], v[24:27]
s_lshl2_add_u32 s14, s29, s75
buffer_load_dwordx4 v[112:115], v245, s[52:55], s14 offen sc1
v_mfma_f32_16x16x32_bf16 v[40:43], v[88:91], v[188:191], v[40:43]
v_mfma_f32_16x16x32_bf16 v[56:59], v[92:95], v[188:191], v[56:59]
v_mfma_f32_16x16x32_bf16 v[72:75], v[96:99], v[188:191], v[72:75]
s_waitcnt vmcnt(29)
v_mfma_f32_16x16x32_bf16 v[12:15], v[80:83], v[192:195], v[12:15]
v_mfma_f32_16x16x32_bf16 v[28:31], v[84:87], v[192:195], v[28:31]
v_mfma_f32_16x16x32_bf16 v[44:47], v[88:91], v[192:195], v[44:47]
v_mfma_f32_16x16x32_bf16 v[60:63], v[92:95], v[192:195], v[60:63]
v_mfma_f32_16x16x32_bf16 v[76:79], v[96:99], v[192:195], v[76:79]
s_waitcnt vmcnt(26)
ds_read_b128 v[80:83], v249 offset:0
ds_read_b128 v[84:87], v249 offset:1024
ds_read_b128 v[88:91], v249 offset:2048
ds_read_b128 v[92:95], v250 offset:0
ds_read_b128 v[96:99], v250 offset:1024
s_mov_b32 exec_hi, 0
buffer_load_dword v252, v253, s[52:55], s15 offen sc1
s_mov_b64 exec, -1
s_waitcnt vmcnt(26) lgkmcnt(5)
v_mfma_f32_16x16x32_bf16 v[0:3], v[160:163], v[116:119], v[0:3]
v_and_b32 v192, 15, v251
v_lshrrev_b32 v193, 4, v251
v_lshlrev_b32 v194, 3, v192
v_mfma_f32_16x16x32_bf16 v[16:19], v[164:167], v[116:119], v[16:19]
v_lshl_add_u32 v195, v193, 14, v194
s_lshl_b32 s14, s68, 2
s_add_u32 s14, s14, s5
v_mfma_f32_16x16x32_bf16 v[32:35], v[168:171], v[116:119], v[32:35]
s_lshl_b32 s10, s14, 7
s_add_u32 s11, s10, 14680064
s_mul_i32 s72, s69, 327680
v_mfma_f32_16x16x32_bf16 v[48:51], v[172:175], v[116:119], v[48:51]
s_add_u32 s72, s72, s10
s_add_u32 s72, s72, 11534336
s_mov_b32 s96, s72
v_mfma_f32_16x16x32_bf16 v[64:67], v[176:179], v[116:119], v[64:67]
s_mov_b32 s97, s11
s_waitcnt vmcnt(25)
v_mfma_f32_16x16x32_bf16 v[4:7], v[160:163], v[120:123], v[4:7]
v_mfma_f32_16x16x32_bf16 v[20:23], v[164:167], v[120:123], v[20:23]
v_mfma_f32_16x16x32_bf16 v[36:39], v[168:171], v[120:123], v[36:39]
v_mfma_f32_16x16x32_bf16 v[52:55], v[172:175], v[120:123], v[52:55]
v_mfma_f32_16x16x32_bf16 v[68:71], v[176:179], v[120:123], v[68:71]
s_waitcnt vmcnt(24)
v_mfma_f32_16x16x32_bf16 v[8:11], v[160:163], v[124:127], v[8:11]
v_mfma_f32_16x16x32_bf16 v[24:27], v[164:167], v[124:127], v[24:27]
v_mfma_f32_16x16x32_bf16 v[40:43], v[168:171], v[124:127], v[40:43]
v_mfma_f32_16x16x32_bf16 v[56:59], v[172:175], v[124:127], v[56:59]
v_mfma_f32_16x16x32_bf16 v[72:75], v[176:179], v[124:127], v[72:75]
s_waitcnt vmcnt(23)
v_mfma_f32_16x16x32_bf16 v[12:15], v[160:163], v[128:131], v[12:15]
v_mfma_f32_16x16x32_bf16 v[28:31], v[164:167], v[128:131], v[28:31]
v_mfma_f32_16x16x32_bf16 v[44:47], v[168:171], v[128:131], v[44:47]
v_mfma_f32_16x16x32_bf16 v[60:63], v[172:175], v[128:131], v[60:63]
v_mfma_f32_16x16x32_bf16 v[76:79], v[176:179], v[128:131], v[76:79]
s_waitcnt vmcnt(22) lgkmcnt(0)
v_mfma_f32_16x16x32_bf16 v[0:3], v[80:83], v[132:135], v[0:3]
s_xor_b32 s10, s5, 1
s_mul_i32 s10, s10, 3072
v_add_u32 v160, s10, v244
v_mfma_f32_16x16x32_bf16 v[16:19], v[84:87], v[132:135], v[16:19]
s_xor_b32 s10, s5, 2
s_mul_i32 s10, s10, 3072
v_add_u32 v161, s10, v244
v_mfma_f32_16x16x32_bf16 v[32:35], v[88:91], v[132:135], v[32:35]
s_xor_b32 s10, s5, 3
s_mul_i32 s10, s10, 3072
v_add_u32 v162, s10, v244
v_mfma_f32_16x16x32_bf16 v[48:51], v[92:95], v[132:135], v[48:51]
s_lshl_b32 s10, s5, 12
s_add_u32 s10, s10, 61440
v_mul_u32_u24 v164, 176, v192
v_mfma_f32_16x16x32_bf16 v[64:67], v[96:99], v[132:135], v[64:67]
v_lshl_add_u32 v164, v193, 3, v164
v_add_u32 v164, s10, v164
s_mov_b32 s11, 0x1999999a
s_waitcnt vmcnt(21)
v_mfma_f32_16x16x32_bf16 v[4:7], v[80:83], v[136:139], v[4:7]
s_mul_i32 s14, s14, 20480
s_mul_i32 s72, s69, 160
s_add_u32 s14, s14, s72
v_mfma_f32_16x16x32_bf16 v[20:23], v[84:87], v[136:139], v[20:23]
v_add_u32 v171, 0, v251
v_mul_hi_u32 v172, v171, s11
v_add_u32 v173, v171, v172
v_mfma_f32_16x16x32_bf16 v[36:39], v[88:91], v[136:139], v[36:39]
v_lshl_add_u32 v165, v173, 4, s10
v_mul_u32_u24 v172, 1120, v172
v_lshl_add_u32 v168, v171, 4, v172
v_mfma_f32_16x16x32_bf16 v[52:55], v[92:95], v[136:139], v[52:55]
v_add_u32 v171, 64, v251
v_mul_hi_u32 v172, v171, s11
v_add_u32 v173, v171, v172
v_mfma_f32_16x16x32_bf16 v[68:71], v[96:99], v[136:139], v[68:71]
v_lshl_add_u32 v166, v173, 4, s10
v_mul_u32_u24 v172, 1120, v172
v_lshl_add_u32 v169, v171, 4, v172
s_waitcnt vmcnt(20)
v_mfma_f32_16x16x32_bf16 v[8:11], v[80:83], v[216:219], v[8:11]
v_add_u32 v171, 128, v251
v_mul_hi_u32 v172, v171, s11
v_add_u32 v173, v171, v172
v_mfma_f32_16x16x32_bf16 v[24:27], v[84:87], v[216:219], v[24:27]
v_lshl_add_u32 v167, v173, 4, s10
v_mul_u32_u24 v172, 1120, v172
v_lshl_add_u32 v170, v171, 4, v172
v_mfma_f32_16x16x32_bf16 v[40:43], v[88:91], v[216:219], v[40:43]
v_lshrrev_b32 v171, 2, v192
v_cmp_eq_u32 vcc, v171, v193
v_mov_b32 v173, 0
v_mfma_f32_16x16x32_bf16 v[56:59], v[92:95], v[216:219], v[56:59]
v_mov_b32 v172, 0x3f80
v_and_b32 v171, 3, v192
v_cndmask_b32 v172, 0, v172, vcc
v_mfma_f32_16x16x32_bf16 v[72:75], v[96:99], v[216:219], v[72:75]
v_lshlrev_b32 v171, 4, v171
v_lshlrev_b64 v[174:175], v171, v[172:173]
s_waitcnt vmcnt(19)
v_mfma_f32_16x16x32_bf16 v[12:15], v[80:83], v[220:223], v[12:15]
v_mfma_f32_16x16x32_bf16 v[28:31], v[84:87], v[220:223], v[28:31]
v_mfma_f32_16x16x32_bf16 v[44:47], v[88:91], v[220:223], v[44:47]
v_mfma_f32_16x16x32_bf16 v[60:63], v[92:95], v[220:223], v[60:63]
v_mfma_f32_16x16x32_bf16 v[76:79], v[96:99], v[220:223], v[76:79]
s_waitcnt vmcnt(0)
s_bfm_b64 exec, 20, 0
s_mov_b32 s8, 0
L_F_A_l:
v_cmp_eq_u32 vcc, 0, v252
s_add_u32 s8, s8, 1
s_cbranch_vccz L_F_A_d
s_cmp_ge_u32 s8, 200000
s_cbranch_scc1 L_F_A_d
buffer_load_dword v252, v253, s[52:55], s15 offen sc1
s_waitcnt vmcnt(0)
s_branch L_F_A_l
L_F_A_d:
s_mov_b64 exec, -1
.p2align 3
v_mfma_f32_16x16x32_bf16 v[4:7], v[224:227], v[228:231], v[4:7]
buffer_load_dwordx2 v[180:181], v195, s[52:55], s96 offen sc1
s_add_u32 s96, s96, 65536
v_mfma_f32_16x16x32_bf16 v[20:23], v[140:143], v[228:231], v[20:23]
buffer_load_dwordx2 v[182:183], v195, s[52:55], s96 offen sc1
s_add_u32 s96, s96, 65536
v_mfma_f32_16x16x32_bf16 v[36:39], v[144:147], v[228:231], v[36:39]
buffer_load_dwordx2 v[184:185], v195, s[52:55], s96 offen sc1
s_add_u32 s96, s96, 65536
v_mfma_f32_16x16x32_bf16 v[52:55], v[148:151], v[228:231], v[52:55]
buffer_load_dwordx2 v[186:187], v195, s[52:55], s96 offen sc1
s_add_u32 s96, s96, 65536
v_mfma_f32_16x16x32_bf16 v[68:71], v[152:155], v[228:231], v[68:71]
buffer_load_dwordx2 v[188:189], v195, s[52:55], s96 offen sc1
s_add_u32 s96, s96, 65536
v_mfma_f32_16x16x32_bf16 v[4:7], v[156:159], v[200:203], v[4:7]
buffer_load_dwordx2 v[190:191], v194, s[52:55], s97 offen sc1
v_mfma_f32_16x16x32_bf16 v[20:23], v[232:235], v[200:203], v[20:23]
v_mfma_f32_16x16x32_bf16 v[36:39], v[236:239], v[200:203], v[36:39]
v_mfma_f32_16x16x32_bf16 v[52:55], v[240:243], v[200:203], v[52:55]
v_mfma_f32_16x16x32_bf16 v[68:71], v[196:199], v[200:203], v[68:71]
v_mfma_f32_16x16x32_bf16 v[8:11], v[224:227], v[204:207], v[8:11]
v_mfma_f32_16x16x32_bf16 v[24:27], v[140:143], v[204:207], v[24:27]
v_mfma_f32_16x16x32_bf16 v[40:43], v[144:147], v[204:207], v[40:43]
v_mfma_f32_16x16x32_bf16 v[56:59], v[148:151], v[204:207], v[56:59]
v_cvt_pk_bf16_f32 v90, v4, v5
v_cvt_pk_bf16_f32 v91, v6, v7
v_mfma_f32_16x16x32_bf16 v[72:75], v[152:155], v[204:207], v[72:75]
v_cvt_pk_bf16_f32 v92, v20, v21
v_cvt_pk_bf16_f32 v93, v22, v23
ds_write_b128 v249, v[90:93] offset:0
v_mfma_f32_16x16x32_bf16 v[8:11], v[156:159], v[208:211], v[8:11]
v_cvt_pk_bf16_f32 v94, v36, v37
v_cvt_pk_bf16_f32 v95, v38, v39
v_mfma_f32_16x16x32_bf16 v[24:27], v[232:235], v[208:211], v[24:27]
v_cvt_pk_bf16_f32 v96, v52, v53
v_cvt_pk_bf16_f32 v97, v54, v55
ds_write_b128 v249, v[94:97] offset:1024
v_mfma_f32_16x16x32_bf16 v[40:43], v[236:239], v[208:211], v[40:43]
v_cvt_pk_bf16_f32 v98, v68, v69
v_cvt_pk_bf16_f32 v99, v70, v71
ds_write_b64 v249, v[98:99] offset:2048
v_mfma_f32_16x16x32_bf16 v[56:59], v[240:243], v[208:211], v[56:59]
v_mfma_f32_16x16x32_bf16 v[72:75], v[196:199], v[208:211], v[72:75]
v_mfma_f32_16x16x32_bf16 v[12:15], v[224:227], v[100:103], v[12:15]
v_mfma_f32_16x16x32_bf16 v[28:31], v[140:143], v[100:103], v[28:31]
v_mfma_f32_16x16x32_bf16 v[44:47], v[144:147], v[100:103], v[44:47]
v_mfma_f32_16x16x32_bf16 v[60:63], v[148:151], v[100:103], v[60:63]
v_cvt_pk_bf16_f32 v80, v8, v9
v_cvt_pk_bf16_f32 v81, v10, v11
v_mfma_f32_16x16x32_bf16 v[76:79], v[152:155], v[100:103], v[76:79]
v_cvt_pk_bf16_f32 v82, v24, v25
v_cvt_pk_bf16_f32 v83, v26, v27
ds_write_b128 v249, v[80:83] offset:12288
v_mfma_f32_16x16x32_bf16 v[12:15], v[156:159], v[104:107], v[12:15]
v_cvt_pk_bf16_f32 v84, v40, v41
v_cvt_pk_bf16_f32 v85, v42, v43
v_mfma_f32_16x16x32_bf16 v[28:31], v[232:235], v[104:107], v[28:31]
v_cvt_pk_bf16_f32 v86, v56, v57
v_cvt_pk_bf16_f32 v87, v58, v59
ds_write_b128 v249, v[84:87] offset:13312
v_mfma_f32_16x16x32_bf16 v[44:47], v[236:239], v[104:107], v[44:47]
v_cvt_pk_bf16_f32 v88, v72, v73
v_cvt_pk_bf16_f32 v89, v74, v75
ds_write_b64 v249, v[88:89] offset:14336
v_mfma_f32_16x16x32_bf16 v[60:63], v[240:243], v[104:107], v[60:63]
v_mfma_f32_16x16x32_bf16 v[76:79], v[196:199], v[104:107], v[76:79]
v_mfma_f32_16x16x32_bf16 v[0:3], v[224:227], v[108:111], v[0:3]
v_mfma_f32_16x16x32_bf16 v[16:19], v[140:143], v[108:111], v[16:19]
v_mfma_f32_16x16x32_bf16 v[32:35], v[144:147], v[108:111], v[32:35]
v_mfma_f32_16x16x32_bf16 v[48:51], v[148:151], v[108:111], v[48:51]
v_cvt_pk_bf16_f32 v90, v12, v13
v_cvt_pk_bf16_f32 v91, v14, v15
v_mfma_f32_16x16x32_bf16 v[64:67], v[152:155], v[108:111], v[64:67]
v_cvt_pk_bf16_f32 v92, v28, v29
v_cvt_pk_bf16_f32 v93, v30, v31
ds_write_b128 v249, v[90:93] offset:24576
v_mfma_f32_16x16x32_bf16 v[0:3], v[156:159], v[112:115], v[0:3]
v_cvt_pk_bf16_f32 v94, v44, v45
v_cvt_pk_bf16_f32 v95, v46, v47
v_mfma_f32_16x16x32_bf16 v[16:19], v[232:235], v[112:115], v[16:19]
v_cvt_pk_bf16_f32 v96, v60, v61
v_cvt_pk_bf16_f32 v97, v62, v63
ds_write_b128 v249, v[94:97] offset:25600
v_mfma_f32_16x16x32_bf16 v[32:35], v[236:239], v[112:115], v[32:35]
v_cvt_pk_bf16_f32 v98, v76, v77
v_cvt_pk_bf16_f32 v99, v78, v79
ds_write_b64 v249, v[98:99] offset:26624
v_mfma_f32_16x16x32_bf16 v[48:51], v[240:243], v[112:115], v[48:51]
v_mfma_f32_16x16x32_bf16 v[64:67], v[196:199], v[112:115], v[64:67]
s_waitcnt lgkmcnt(0)
s_barrier
ds_read_b128 v[4:7], v160 offset:0
ds_read_b128 v[8:11], v161 offset:12288
ds_read_b128 v[12:15], v162 offset:24576
ds_read_b128 v[20:23], v160 offset:1024
ds_read_b128 v[24:27], v161 offset:13312
ds_read_b128 v[28:31], v162 offset:25600
ds_read_b64 v[36:37], v160 offset:2048
ds_read_b64 v[40:41], v161 offset:14336
ds_read_b64 v[44:45], v162 offset:26624
s_waitcnt vmcnt(0)
v_lshlrev_b32 v80, 16, v180
v_and_b32 v81, 0xffff0000, v180
v_lshlrev_b32 v82, 16, v181
v_and_b32 v83, 0xffff0000, v181
v_mul_f32 v80, v190, v80
v_mul_f32 v81, v190, v81
v_mul_f32 v82, v190, v82
v_mul_f32 v83, v190, v83
v_lshlrev_b32 v84, 16, v182
v_and_b32 v85, 0xffff0000, v182
v_lshlrev_b32 v86, 16, v183
v_and_b32 v87, 0xffff0000, v183
v_mul_f32 v84, v190, v84
v_mul_f32 v85, v190, v85
v_mul_f32 v86, v190, v86
v_mul_f32 v87, v190, v87
v_lshlrev_b32 v88, 16, v184
v_and_b32 v89, 0xffff0000, v184
v_lshlrev_b32 v90, 16, v185
v_and_b32 v91, 0xffff0000, v185
v_mul_f32 v88, v190, v88
v_mul_f32 v89, v190, v89
v_mul_f32 v90, v190, v90
v_mul_f32 v91, v190, v91
v_lshlrev_b32 v92, 16, v186
v_and_b32 v93, 0xffff0000, v186
v_lshlrev_b32 v94, 16, v187
v_and_b32 v95, 0xffff0000, v187
v_mul_f32 v92, v190, v92
v_mul_f32 v93, v190, v93
v_mul_f32 v94, v190, v94
v_mul_f32 v95, v190, v95
v_lshlrev_b32 v96, 16, v188
v_and_b32 v97, 0xffff0000, v188
v_lshlrev_b32 v98, 16, v189
v_and_b32 v99, 0xffff0000, v189
v_mul_f32 v96, v190, v96
v_mul_f32 v97, v190, v97
v_mul_f32 v98, v190, v98
v_mul_f32 v99, v190, v99
s_waitcnt lgkmcnt(8)
v_mfma_f32_16x16x16_bf16 v[0:3], v[174:175], v[4:5], v[0:3]
v_mfma_f32_16x16x16_bf16 v[16:19], v[174:175], v[6:7], v[16:19]
s_waitcnt lgkmcnt(7)
v_mfma_f32_16x16x16_bf16 v[0:3], v[174:175], v[8:9], v[0:3]
v_mfma_f32_16x16x16_bf16 v[16:19], v[174:175], v[10:11], v[16:19]
s_waitcnt lgkmcnt(6)
v_mfma_f32_16x16x16_bf16 v[0:3], v[174:175], v[12:13], v[0:3]
v_mfma_f32_16x16x16_bf16 v[16:19], v[174:175], v[14:15], v[16:19]
s_waitcnt lgkmcnt(2)
v_mfma_f32_16x16x16_bf16 v[32:35], v[174:175], v[20:21], v[32:35]
v_mfma_f32_16x16x16_bf16 v[48:51], v[174:175], v[22:23], v[48:51]
v_mfma_f32_16x16x16_bf16 v[64:67], v[174:175], v[36:37], v[64:67]
s_waitcnt lgkmcnt(1)
v_mfma_f32_16x16x16_bf16 v[32:35], v[174:175], v[24:25], v[32:35]
v_mfma_f32_16x16x16_bf16 v[48:51], v[174:175], v[26:27], v[48:51]
v_mfma_f32_16x16x16_bf16 v[64:67], v[174:175], v[40:41], v[64:67]
s_waitcnt lgkmcnt(0)
v_mfma_f32_16x16x16_bf16 v[32:35], v[174:175], v[28:29], v[32:35]
v_mfma_f32_16x16x16_bf16 v[48:51], v[174:175], v[30:31], v[48:51]
v_mfma_f32_16x16x16_bf16 v[64:67], v[174:175], v[44:45], v[64:67]
v_fmac_f32 v80, v191, v0
v_fmac_f32 v81, v191, v1
v_fmac_f32 v82, v191, v2
v_fmac_f32 v83, v191, v3
v_cvt_pk_bf16_f32 v80, v80, v81
v_cvt_pk_bf16_f32 v81, v82, v83
ds_write_b64 v164, v[80:81] offset:0
v_fmac_f32 v84, v191, v16
v_fmac_f32 v85, v191, v17
v_fmac_f32 v86, v191, v18
v_fmac_f32 v87, v191, v19
v_cvt_pk_bf16_f32 v84, v84, v85
v_cvt_pk_bf16_f32 v85, v86, v87
ds_write_b64 v164, v[84:85] offset:32
v_fmac_f32 v88, v191, v32
v_fmac_f32 v89, v191, v33
v_fmac_f32 v90, v191, v34
v_fmac_f32 v91, v191, v35
v_cvt_pk_bf16_f32 v88, v88, v89
v_cvt_pk_bf16_f32 v89, v90, v91
ds_write_b64 v164, v[88:89] offset:64
v_fmac_f32 v92, v191, v48
v_fmac_f32 v93, v191, v49
v_fmac_f32 v94, v191, v50
v_fmac_f32 v95, v191, v51
v_cvt_pk_bf16_f32 v92, v92, v93
v_cvt_pk_bf16_f32 v93, v94, v95
ds_write_b64 v164, v[92:93] offset:96
v_fmac_f32 v96, v191, v64
v_fmac_f32 v97, v191, v65
v_fmac_f32 v98, v191, v66
v_fmac_f32 v99, v191, v67
v_cvt_pk_bf16_f32 v96, v96, v97
v_cvt_pk_bf16_f32 v97, v98, v99
ds_write_b64 v164, v[96:97] offset:128
ds_read_b128 v[100:103], v165
ds_read_b128 v[104:107], v166
ds_read_b128 v[108:111], v167
s_waitcnt lgkmcnt(2)
buffer_store_dwordx4 v[100:103], v168, s[76:79], s14 offen
s_waitcnt lgkmcnt(1)
buffer_store_dwordx4 v[104:107], v169, s[76:79], s14 offen
s_waitcnt lgkmcnt(0)
s_mov_b32 exec_hi, 0
buffer_store_dwordx4 v[108:111], v170, s[76:79], s14 offen
s_endpgm
L_F_end:
.p2align 3
L_C:
s_setprio 3
s_getpc_b64 s[6:7]
L_C_pc:
s_sub_u32 s8, s4, 12
s_lshl_b32 s8, s8, 2
s_add_u32 s8, s8, s5
s_lshl_b32 s8, s8, 7
s_min_u32 s8, s8, L_C_end-L_C_pc-4
v_mov_b32 v3, s8
global_load_dword v255, v3, s[6:7]
s_mul_i32 s10, s3, 20
s_add_u32 s10, s10, s4
s_sub_u32 s10, s10, 12
s_lshl_b32 s11, s10, 2
s_add_u32 s11, s11, s5
s_mul_i32 s12, s11, 384
v_lshl_add_u32 v2, v1, 2, s12
v_lshl_add_u32 v3, v1, 1, s12
s_and_b32 s13, s11, -2
s_lshl_b32 s13, s13, 1
s_waitcnt lgkmcnt(0)
global_load_dword v10, v2, s[18:19]
global_load_dword v11, v2, s[20:21]
global_load_dword v12, v2, s[22:23]
global_load_dword v13, v2, s[24:25]
global_load_dword v14, v2, s[26:27]
global_load_dword v15, v2, s[28:29]
s_load_dword s14, s[30:31], s13
s_load_dword s15, s[32:33], s13
global_load_ushort v16, v3, s[18:19] offset:256
global_load_ushort v17, v3, s[20:21] offset:256
global_load_ushort v18, v3, s[22:23] offset:256
global_load_ushort v19, v3, s[24:25] offset:256
global_load_ushort v20, v3, s[26:27] offset:256
global_load_ushort v21, v3, s[28:29] offset:256
s_bitcmp1_b32 s11, 0
s_cselect_b32 s60, s38, s36
s_cselect_b32 s61, s39, s37
s_mov_b32 s62, 1966080
s_mov_b32 s63, 0x20000
s_lshr_b32 s64, s11, 1
s_mul_i32 s64, s64, 6144
v_min_u32 v253, 47, v1
v_lshlrev_b32 v253, 7, v253
s_mov_b32 s52, s48
s_mov_b32 s53, s49
s_mov_b32 s54, 16777216
s_mov_b32 s55, 0x20000
s_mov_b32 s56, s46
s_mov_b32 s57, s47
s_mov_b32 s58, 256
s_mov_b32 s59, 0x20000
s_setprio 0
s_mul_i32 s12, s5, 20480
v_mul_u32_u24 v40, 144, v1
v_add_u32 v40, s12, v40
v_and_b32 v4, 31, v1
v_lshrrev_b32 v5, 5, v1
v_and_b32 v6, 12, v1
v_add_u32 v6, v6, v5
v_mul_u32_u24 v41, 144, v6
v_and_b32 v6, 16, v1
v_lshl_add_u32 v41, v6, 1, v41
v_and_b32 v6, 3, v1
v_lshl_add_u32 v41, v6, 3, v41
v_add_u32 v41, s12, v41
v_mov_b32 v160, 0
v_mov_b32 v161, 0
v_mov_b32 v162, 0
v_mov_b32 v163, 0
v_mov_b32 v164, 0
v_mov_b32 v165, 0
v_mov_b32 v166, 0
v_mov_b32 v167, 0
v_mov_b32 v168, 0
v_mov_b32 v169, 0
v_mov_b32 v170, 0
v_mov_b32 v171, 0
v_mov_b32 v172, 0
v_mov_b32 v173, 0
v_mov_b32 v174, 0
v_mov_b32 v175, 0
s_mul_i32 s69, s5, 20512
s_add_u32 s69, s69, 9216
v_lshl_add_u32 v48, v1, 4, s69
ds_write_b128 v48, v[160:163] offset:9216
ds_write_b128 v48, v[160:163] offset:9776
v_lshlrev_b32 v42, 9, v5
v_lshl_add_u32 v42, v4, 4, v42
v_add_u32 v42, s12, v42
v_mul_u32_u24 v7, 20512, v6
v_lshrrev_b32 v6, 4, v0
v_mul_u32_u24 v6, 144, v6
v_bfe_u32 v9, v0, 2, 2
v_lshlrev_b32 v8, 4, v9
v_cmp_eq_u32 vcc, 0, v9
v_add3_u32 v7, v7, v6, v8
v_mov_b32 v8, 80
v_cndmask_b32 v8, v8, 0, vcc
v_add_u32 v8, v8, v7
s_lshl_b32 s50, s10, 14
s_add_u32 s51, s50, 8388608
v_lshlrev_b32 v9, 4, v0
v_and_b32 v59, 15, v1
v_lshrrev_b32 v60, 4, v1
v_lshlrev_b32 v61, 2, v60
v_sub_u32 v62, v59, v61
s_add_u32 s13, s12, 6272
v_lshl_add_u32 v94, v62, 5, s13
v_add_u32 v95, 1024, v94
v_lshl_add_u32 v249, v1, 1, s12
v_mov_b32 v248, 0
v_cmp_le_i32_e64 s[40:41], 0, v62
v_cmp_le_i32_e64 s[42:43], 1, v62
v_cmp_le_i32_e64 s[44:45], 2, v62
v_cmp_le_i32_e64 s[46:47], 3, v62
v_lshlrev_b32 v63, 4, v59
v_sub_u32 v63, v61, v63
v_add_u32 v64, 1268, v63
v_lshrrev_b32 v65, 5, v64
v_and_b32 v64, 31, v64
v_mul_u32_u24 v65, 144, v65
v_lshlrev_b32 v64, 1, v64
v_add3_u32 v250, v65, v64, s69
v_add_u32 v64, 1284, v63
v_lshrrev_b32 v65, 5, v64
v_and_b32 v64, 31, v64
v_mul_u32_u24 v65, 144, v65
v_lshlrev_b32 v64, 1, v64
v_add3_u32 v251, v65, v64, s69
v_add_u32 v63, v59, v61
s_mov_b32 s13, 0x10001
v_mov_b32 v64, 8323072
v_lshrrev_b32 v64, v63, v64
v_bfe_u32 v240, v64, 0, 2
v_lshl_or_b32 v240, v240, 15, v240
v_and_b32 v240, s13, v240
v_mul_u32_u24 v240, 0x3f80, v240
v_bfe_u32 v241, v64, 2, 2
v_lshl_or_b32 v241, v241, 15, v241
v_and_b32 v241, s13, v241
v_mul_u32_u24 v241, 0x3f80, v241
v_bfe_u32 v242, v64, 16, 2
v_lshl_or_b32 v242, v242, 15, v242
v_and_b32 v242, s13, v242
v_mul_u32_u24 v242, 0x3f80, v242
v_bfe_u32 v243, v64, 18, 2
v_lshl_or_b32 v243, v243, 15, v243
v_and_b32 v243, s13, v243
v_mul_u32_u24 v243, 0x3f80, v243
v_mov_b32 v64, 4286578688
v_lshrrev_b32 v64, v63, v64
v_bfe_u32 v244, v64, 0, 2
v_lshl_or_b32 v244, v244, 15, v244
v_and_b32 v244, s13, v244
v_mul_u32_u24 v244, 0x3f80, v244
v_bfe_u32 v245, v64, 2, 2
v_lshl_or_b32 v245, v245, 15, v245
v_and_b32 v245, s13, v245
v_mul_u32_u24 v245, 0x3f80, v245
v_bfe_u32 v246, v64, 16, 2
v_lshl_or_b32 v246, v246, 15, v246
v_and_b32 v246, s13, v246
v_mul_u32_u24 v246, 0x3f80, v246
v_bfe_u32 v247, v64, 18, 2
v_lshl_or_b32 v247, v247, 15, v247
v_and_b32 v247, s13, v247
v_mul_u32_u24 v247, 0x3f80, v247
v_bfe_u32 v63, v1, 2, 1
v_bfe_u32 v64, v1, 3, 1
v_lshlrev_b32 v63, 4, v63
v_lshl_or_b32 v63, v64, 6, v63
v_lshlrev_b32 v252, 6, v59
v_lshl_add_u32 v252, v60, 4, v252
v_xor_b32 v252, v252, v63
v_add_u32 v252, s12, v252
v_bfe_u32 v64, v1, 1, 3
v_and_b32 v65, 1, v1
v_lshlrev_b32 v92, 7, v64
v_lshl_add_u32 v92, v65, 3, v92
v_lshl_add_u32 v92, v60, 5, v92
v_xor_b32 v92, v92, v63
v_add_u32 v92, s12, v92
v_xor_b32 v93, 16, v92
s_waitcnt lgkmcnt(0)
s_and_b32 s13, s11, 1
s_lshl_b32 s13, s13, 4
s_lshr_b32 s14, s14, s13
s_lshl_b32 s14, s14, 16
s_lshr_b32 s15, s15, s13
s_lshl_b32 s15, s15, 16
v_mov_b32 v44, 0x3fb8aa3b
v_mul_f32 v44, s14, v44
v_exp_f32 v44, v44
v_cmp_eq_u32 vcc, 0, v1
v_mov_b32 v43, s15
v_cvt_pk_bf16_f32 v44, v44, v44
v_cndmask_b32 v43, 0, v43, vcc
v_lshlrev_b32 v44, 16, v44
s_nop 0
v_readfirstlane_b32 s14, v44
s_waitcnt vmcnt(6)
buffer_load_dword v254, v253, s[60:63], s64 offen
v_lshlrev_b32 v22, 16, v10
v_and_b32 v28, 0xffff0000, v10
v_lshlrev_b32 v23, 16, v11
v_and_b32 v29, 0xffff0000, v11
v_lshlrev_b32 v24, 16, v12
v_and_b32 v30, 0xffff0000, v12
v_lshlrev_b32 v25, 16, v13
v_and_b32 v31, 0xffff0000, v13
v_lshlrev_b32 v26, 16, v14
v_and_b32 v32, 0xffff0000, v14
v_lshlrev_b32 v27, 16, v15
v_and_b32 v33, 0xffff0000, v15
s_waitcnt vmcnt(1)
v_lshlrev_b32 v34, 16, v16
v_lshlrev_b32 v35, 16, v17
v_lshlrev_b32 v36, 16, v18
v_lshlrev_b32 v37, 16, v19
v_lshlrev_b32 v38, 16, v20
v_lshlrev_b32 v39, 16, v21
s_lshl_b32 s68, s3, 8
s_add_u32 s68, s68, 14755840
v_lshlrev_b32 v193, 2, v1
s_mov_b32 s70, 0x3fb8aa3b
s_mov_b32 s71, 0x41000000
s_mov_b32 s72, 0x43800000
v_mul_f32 v22, s14, v22
v_mul_f32 v23, s14, v23
v_mul_f32 v24, s14, v24
v_mul_f32 v25, s14, v25
v_mul_f32 v22, s70, v22
v_mul_f32 v23, 0.15915494, v23
v_mul_f32 v59, s71, v22
v_mul_f32 v61, s71, v23
v_mul_f32 v60, s72, v22
v_mul_f32 v62, s72, v23
v_exp_f32 v59, v59
v_fract_f32 v61, v61
v_exp_f32 v22, v22
v_fract_f32 v23, v23
v_exp_f32 v60, v60
v_fract_f32 v62, v62
v_cos_f32 v47, v61
v_mul_f32 v64, v26, v24
v_sin_f32 v48, v61
v_mul_f32 v65, v26, v25
v_cos_f32 v44, v23
v_mul_f32 v63, v27, v25
v_sin_f32 v45, v23
v_fmac_f32 v65, v27, v24
v_cos_f32 v50, v62
v_mul_f32 v47, v59, v47
v_sin_f32 v51, v62
v_mul_f32 v48, v59, v48
v_mul_f32 v44, v22, v44
v_mul_f32 v45, v22, v45
v_mul_f32 v50, v60, v50
v_mul_f32 v51, v60, v51
v_sub_f32 v49, 0, v48
v_sub_f32 v46, 0, v45
v_sub_f32 v52, 0, v51
v_sub_f32 v64, v64, v63
v_mul_f32 v80, v47, v47
v_mov_b32 v22, v28
v_mul_f32 v81, v48, v47
v_mov_b32 v23, v29
v_fmac_f32 v80, v48, v49
v_mov_b32 v24, v30
v_fmac_f32 v81, v47, v48
v_mov_b32 v25, v31
v_mov_b32 v26, v32
v_mov_b32 v27, v33
v_sub_f32 v82, 0, v81
v_mov_b32 v28, v34
v_mov_b32 v29, v35
v_mov_b32 v30, v36
v_mov_b32 v31, v37
v_mov_b32 v32, v38
v_mov_b32 v33, v39
s_mov_b32 s13, 0
.p2align 3
L_C_k:
v_cvt_pk_bf16_f32 v196, 1.0, v47
v_cvt_pk_bf16_f32 v200, 0, v49
v_mul_f32 v72, v47, v80
v_mul_f32 v73, v49, v80
v_fmac_f32 v72, v49, v81
v_fmac_f32 v73, v47, v82
v_cvt_pk_bf16_f32 v197, v80, v72
v_cvt_pk_bf16_f32 v201, v82, v73
v_mul_f32 v66, v80, v80
v_mul_f32 v70, v72, v80
v_mul_f32 v67, v82, v80
v_mul_f32 v71, v73, v80
v_fmac_f32 v66, v82, v81
v_fmac_f32 v70, v73, v81
v_fmac_f32 v67, v80, v82
v_fmac_f32 v71, v72, v82
v_cvt_pk_bf16_f32 v198, v66, v70
v_cvt_pk_bf16_f32 v202, v67, v71
v_mul_f32 v68, v66, v80
v_mul_f32 v72, v70, v80
v_mul_f32 v69, v67, v80
v_mul_f32 v73, v71, v80
v_fmac_f32 v68, v67, v81
v_fmac_f32 v72, v71, v81
v_fmac_f32 v69, v66, v82
v_fmac_f32 v73, v70, v82
v_cvt_pk_bf16_f32 v199, v68, v72
v_cvt_pk_bf16_f32 v203, v69, v73
ds_write_b128 v40, v[196:199] offset:0
ds_write_b128 v40, v[200:203] offset:64
v_mul_f32 v66, v68, v80
v_mul_f32 v70, v72, v80
v_mul_f32 v67, v69, v80
v_mul_f32 v71, v73, v80
v_fmac_f32 v66, v69, v81
v_fmac_f32 v70, v73, v81
v_fmac_f32 v67, v68, v82
v_fmac_f32 v71, v72, v82
v_cvt_pk_bf16_f32 v204, v66, v70
v_cvt_pk_bf16_f32 v208, v67, v71
v_mul_f32 v68, v66, v80
v_mul_f32 v72, v70, v80
v_mul_f32 v69, v67, v80
v_mul_f32 v73, v71, v80
v_fmac_f32 v68, v67, v81
v_fmac_f32 v72, v71, v81
v_fmac_f32 v69, v66, v82
v_fmac_f32 v73, v70, v82
v_cvt_pk_bf16_f32 v205, v68, v72
v_cvt_pk_bf16_f32 v209, v69, v73
v_mul_f32 v66, v68, v80
v_mul_f32 v70, v72, v80
v_mul_f32 v67, v69, v80
v_mul_f32 v71, v73, v80
v_fmac_f32 v66, v69, v81
v_fmac_f32 v70, v73, v81
v_fmac_f32 v67, v68, v82
v_fmac_f32 v71, v72, v82
v_cvt_pk_bf16_f32 v206, v66, v70
v_cvt_pk_bf16_f32 v210, v67, v71
v_mul_f32 v68, v66, v80
v_mul_f32 v72, v70, v80
v_mul_f32 v69, v67, v80
v_mul_f32 v73, v71, v80
v_fmac_f32 v68, v67, v81
v_fmac_f32 v72, v71, v81
v_fmac_f32 v69, v66, v82
v_fmac_f32 v73, v70, v82
v_cvt_pk_bf16_f32 v207, v68, v72
v_cvt_pk_bf16_f32 v211, v69, v73
ds_write_b128 v40, v[204:207] offset:16
ds_write_b128 v40, v[208:211] offset:80
v_mul_f32 v66, v68, v80
v_mul_f32 v70, v72, v80
v_mul_f32 v67, v69, v80
v_mul_f32 v71, v73, v80
v_fmac_f32 v66, v69, v81
v_fmac_f32 v70, v73, v81
v_fmac_f32 v67, v68, v82
v_fmac_f32 v71, v72, v82
v_cvt_pk_bf16_f32 v196, v66, v70
v_cvt_pk_bf16_f32 v200, v67, v71
v_mul_f32 v68, v66, v80
v_mul_f32 v72, v70, v80
v_mul_f32 v69, v67, v80
v_mul_f32 v73, v71, v80
v_fmac_f32 v68, v67, v81
v_fmac_f32 v72, v71, v81
v_fmac_f32 v69, v66, v82
v_fmac_f32 v73, v70, v82
v_cvt_pk_bf16_f32 v197, v68, v72
v_cvt_pk_bf16_f32 v201, v69, v73
v_mul_f32 v66, v68, v80
v_mul_f32 v70, v72, v80
v_mul_f32 v67, v69, v80
v_mul_f32 v71, v73, v80
v_fmac_f32 v66, v69, v81
v_fmac_f32 v70, v73, v81
v_fmac_f32 v67, v68, v82
v_fmac_f32 v71, v72, v82
v_cvt_pk_bf16_f32 v198, v66, v70
v_cvt_pk_bf16_f32 v202, v67, v71
v_mul_f32 v68, v66, v80
v_mul_f32 v72, v70, v80
v_mul_f32 v69, v67, v80
v_mul_f32 v73, v71, v80
v_fmac_f32 v68, v67, v81
v_fmac_f32 v72, v71, v81
v_fmac_f32 v69, v66, v82
v_fmac_f32 v73, v70, v82
v_cvt_pk_bf16_f32 v199, v68, v72
v_cvt_pk_bf16_f32 v203, v69, v73
ds_write_b128 v40, v[196:199] offset:32
ds_write_b128 v40, v[200:203] offset:96
v_mul_f32 v66, v68, v80
v_mul_f32 v70, v72, v80
v_mul_f32 v67, v69, v80
v_mul_f32 v71, v73, v80
v_fmac_f32 v66, v69, v81
v_fmac_f32 v70, v73, v81
v_fmac_f32 v67, v68, v82
v_fmac_f32 v71, v72, v82
v_cvt_pk_bf16_f32 v204, v66, v70
v_cvt_pk_bf16_f32 v208, v67, v71
v_mul_f32 v68, v66, v80
v_mul_f32 v72, v70, v80
v_mul_f32 v69, v67, v80
v_mul_f32 v73, v71, v80
v_fmac_f32 v68, v67, v81
v_fmac_f32 v72, v71, v81
v_fmac_f32 v69, v66, v82
v_fmac_f32 v73, v70, v82
v_cvt_pk_bf16_f32 v205, v68, v72
v_cvt_pk_bf16_f32 v209, v69, v73
v_mul_f32 v66, v68, v80
v_mul_f32 v70, v72, v80
v_mul_f32 v67, v69, v80
v_mul_f32 v71, v73, v80
v_fmac_f32 v66, v69, v81
v_fmac_f32 v70, v73, v81
v_fmac_f32 v67, v68, v82
v_fmac_f32 v71, v72, v82
v_cvt_pk_bf16_f32 v206, v66, v70
v_cvt_pk_bf16_f32 v210, v67, v71
v_mul_f32 v68, v66, v80
v_mul_f32 v72, v70, v80
v_mul_f32 v69, v67, v80
v_mul_f32 v73, v71, v80
v_fmac_f32 v68, v67, v81
v_fmac_f32 v72, v71, v81
v_fmac_f32 v69, v66, v82
v_fmac_f32 v73, v70, v82
v_cvt_pk_bf16_f32 v207, v68, v72
v_cvt_pk_bf16_f32 v211, v69, v73
ds_write_b128 v40, v[204:207] offset:48
ds_write_b128 v40, v[208:211] offset:112
ds_read_b64_tr_b16 v[128:129], v41 offset:0
ds_read_b64_tr_b16 v[130:131], v41 offset:64
ds_read_b64_tr_b16 v[132:133], v41 offset:288
ds_read_b64_tr_b16 v[134:135], v41 offset:352
ds_read_b64_tr_b16 v[136:137], v41 offset:2304
ds_read_b64_tr_b16 v[138:139], v41 offset:2368
ds_read_b64_tr_b16 v[140:141], v41 offset:2592
ds_read_b64_tr_b16 v[142:143], v41 offset:2656
ds_read_b64_tr_b16 v[144:145], v41 offset:4608
ds_read_b64_tr_b16 v[146:147], v41 offset:4672
ds_read_b64_tr_b16 v[148:149], v41 offset:4896
ds_read_b64_tr_b16 v[150:151], v41 offset:4960
ds_read_b64_tr_b16 v[152:153], v41 offset:6912
ds_read_b64_tr_b16 v[154:155], v41 offset:6976
ds_read_b64_tr_b16 v[156:157], v41 offset:7200
ds_read_b64_tr_b16 v[158:159], v41 offset:7264
s_cmp_lg_u32 s13, 2
s_cbranch_scc1 L_C_q
s_cmp_lg_u32 s5, 0
s_cbranch_scc1 L_C_p
s_waitcnt vmcnt(0)
s_mov_b32 s8, 0
L_C_T_l:
v_cmp_eq_u32 vcc, 0, v192
s_add_u32 s8, s8, 1
s_cbranch_vccz L_C_T_d
s_cmp_ge_u32 s8, 200000
s_cbranch_scc1 L_C_T_d
buffer_load_dword v192, v193, s[52:55], s68 offen sc1
s_waitcnt vmcnt(0)
s_branch L_C_T_l
L_C_T_d:
s_mov_b64 exec, -1
L_C_p:
s_barrier
buffer_load_dwordx4 v[176:179], v9, s[52:55], s51 offen sc1
s_add_u32 s51, s51, 4096
buffer_load_dwordx4 v[180:183], v9, s[52:55], s51 offen sc1
s_add_u32 s51, s51, 4096
buffer_load_dwordx4 v[184:187], v9, s[52:55], s51 offen sc1
s_add_u32 s51, s51, 4096
buffer_load_dwordx4 v[188:191], v9, s[52:55], s51 offen sc1
s_add_u32 s51, s51, 4096
L_C_q:
.p2align 3
v_mul_f32 v96, v64, v44
v_mul_f32 v98, v64, v50
v_mul_f32 v97, v65, v44
v_mul_f32 v99, v65, v50
v_fmac_f32 v96, v65, v46
v_fmac_f32 v98, v65, v52
v_fmac_f32 v97, v64, v45
v_fmac_f32 v99, v64, v51
v_cvt_pk_bf16_f32 v212, v64, v96
v_cvt_pk_bf16_f32 v216, v65, v97
v_cvt_pk_bf16_f32 v214, v98, v98
v_cvt_pk_bf16_f32 v218, v99, v99
v_mul_f32 v100, v96, v44
v_mul_f32 v102, v98, v50
v_mul_f32 v101, v97, v44
v_mul_f32 v103, v99, v50
v_fmac_f32 v100, v97, v46
v_fmac_f32 v102, v99, v52
v_fmac_f32 v101, v96, v45
v_fmac_f32 v103, v98, v51
v_mul_f32 v104, v100, v50
v_mul_f32 v106, v102, v50
v_mul_f32 v105, v101, v50
v_mul_f32 v107, v103, v50
v_fmac_f32 v104, v101, v52
v_fmac_f32 v106, v103, v52
v_fmac_f32 v105, v100, v51
v_fmac_f32 v107, v102, v51
v_mul_f32 v108, v100, v44
v_mul_f32 v110, v106, v50
v_mul_f32 v109, v101, v44
v_mul_f32 v111, v107, v50
v_fmac_f32 v108, v101, v46
v_fmac_f32 v110, v107, v52
v_fmac_f32 v109, v100, v45
v_fmac_f32 v111, v106, v51
v_cvt_pk_bf16_f32 v213, v100, v108
v_cvt_pk_bf16_f32 v217, v101, v109
v_mul_f32 v112, v108, v44
v_mul_f32 v114, v110, v50
v_mul_f32 v113, v109, v44
v_mul_f32 v115, v111, v50
v_fmac_f32 v112, v109, v46
v_fmac_f32 v114, v111, v52
v_fmac_f32 v113, v108, v45
v_fmac_f32 v115, v110, v51
v_mul_f32 v116, v112, v50
v_mul_f32 v118, v114, v50
v_mul_f32 v117, v113, v50
v_mul_f32 v119, v115, v50
v_fmac_f32 v116, v113, v52
v_fmac_f32 v118, v115, v52
v_fmac_f32 v117, v112, v51
v_fmac_f32 v119, v114, v51
v_cvt_pk_bf16_f32 v215, v104, v116
v_cvt_pk_bf16_f32 v219, v105, v117
ds_write_b128 v40, v[212:215] offset:0
ds_write_b128 v40, v[216:219] offset:64
v_cvt_pk_bf16_f32 v222, v116, v116
v_cvt_pk_bf16_f32 v226, v117, v117
v_cvt_pk_bf16_f32 v229, v110, v118
v_cvt_pk_bf16_f32 v233, v111, v119
v_mul_f32 v120, v112, v44
v_mul_f32 v122, v118, v50
v_mul_f32 v121, v113, v44
v_mul_f32 v123, v119, v50
v_fmac_f32 v120, v113, v46
v_fmac_f32 v122, v119, v52
v_fmac_f32 v121, v112, v45
v_fmac_f32 v123, v118, v51
v_cvt_pk_bf16_f32 v220, v112, v120
v_cvt_pk_bf16_f32 v224, v113, v121
v_cvt_pk_bf16_f32 v231, v114, v122
v_cvt_pk_bf16_f32 v235, v115, v123
v_mul_f32 v124, v120, v44
v_mul_f32 v126, v116, v50
v_mul_f32 v125, v121, v44
v_mul_f32 v127, v117, v50
v_fmac_f32 v124, v121, v46
v_fmac_f32 v126, v117, v52
v_fmac_f32 v125, v120, v45
v_fmac_f32 v127, v116, v51
v_cvt_pk_bf16_f32 v228, v102, v126
v_cvt_pk_bf16_f32 v232, v103, v127
v_mul_f32 v96, v124, v50
v_mul_f32 v98, v126, v50
v_mul_f32 v97, v125, v50
v_mul_f32 v99, v127, v50
v_fmac_f32 v96, v125, v52
v_fmac_f32 v98, v127, v52
v_fmac_f32 v97, v124, v51
v_fmac_f32 v99, v126, v51
v_cvt_pk_bf16_f32 v230, v106, v98
v_cvt_pk_bf16_f32 v234, v107, v99
ds_write_b128 v40, v[228:231] offset:32
ds_write_b128 v40, v[232:235] offset:96
v_mul_f32 v100, v124, v44
v_mul_f32 v108, v122, v50
v_mul_f32 v101, v125, v44
v_mul_f32 v109, v123, v50
v_fmac_f32 v100, v125, v46
v_fmac_f32 v108, v123, v52
v_fmac_f32 v101, v124, v45
v_fmac_f32 v109, v122, v51
v_cvt_pk_bf16_f32 v221, v124, v100
v_cvt_pk_bf16_f32 v225, v125, v101
v_cvt_pk_bf16_f32 v223, v96, v108
v_cvt_pk_bf16_f32 v227, v97, v109
ds_write_b128 v40, v[220:223] offset:16
ds_write_b128 v40, v[224:227] offset:80
ds_read_b64_tr_b16 v[96:97], v41 offset:0
ds_read_b64_tr_b16 v[98:99], v41 offset:64
ds_read_b64_tr_b16 v[100:101], v41 offset:288
ds_read_b64_tr_b16 v[102:103], v41 offset:352
ds_read_b64_tr_b16 v[104:105], v41 offset:2304
ds_read_b64_tr_b16 v[106:107], v41 offset:2368
ds_read_b64_tr_b16 v[108:109], v41 offset:2592
ds_read_b64_tr_b16 v[110:111], v41 offset:2656
ds_read_b64_tr_b16 v[112:113], v41 offset:4608
ds_read_b64_tr_b16 v[114:115], v41 offset:4672
ds_read_b64_tr_b16 v[116:117], v41 offset:4896
ds_read_b64_tr_b16 v[118:119], v41 offset:4960
ds_read_b64_tr_b16 v[120:121], v41 offset:6912
ds_read_b64_tr_b16 v[122:123], v41 offset:6976
ds_read_b64_tr_b16 v[124:125], v41 offset:7200
ds_read_b64_tr_b16 v[126:127], v41 offset:7264
s_add_u32 s13, s13, 1
s_cmp_lg_u32 s13, 1
s_cbranch_scc1 L_C_i
s_cmp_lg_u32 s5, 0
s_cbranch_scc1 L_C_i
s_bfm_b64 exec, 1, 0
buffer_load_dword v194, off, s[56:59], 0 sc1
s_mov_b64 exec, -1
L_C_i:
s_cmp_lg_u32 s13, 2
s_cbranch_scc1 L_C_j
s_cmp_lg_u32 s5, 0
s_cbranch_scc1 L_C_j
s_bfm_b64 exec, 1, 0
s_waitcnt vmcnt(0)
s_mov_b32 s8, 0
L_C_I_l:
v_cmp_eq_u32 vcc, 0, v194
s_add_u32 s8, s8, 1
s_cbranch_vccz L_C_I_d
s_cmp_ge_u32 s8, 200000
s_cbranch_scc1 L_C_I_d
buffer_load_dword v194, off, s[56:59], 0 sc1
s_waitcnt vmcnt(0)
s_branch L_C_I_l
L_C_I_d:
s_mov_b64 exec, -1
buffer_load_dword v192, v193, s[52:55], s68 offen sc1
s_mov_b64 exec, -1
L_C_j:
s_cmp_lg_u32 s13, 3
s_cbranch_scc1 L_C_k0
v_mov_b32 v44, 0
v_lshl_add_u32 v40, v1, 2, s12
v_and_b32 v10, 1, v1
v_cmp_eq_u32 vcc, 0, v10
v_bfe_u32 v11, v1, 1, 3
v_lshrrev_b32 v12, 4, v1
v_mov_b32 v13, 4240
v_cndmask_b32 v13, 8, v13, vcc
v_add_u32 v14, v11, v12
v_lshl_add_u32 v2, v14, 3, v13
v_add_u32 v2, s12, v2
v_mov_b32 v13, 640
v_cndmask_b32 v13, 0, v13, vcc
v_sub_u32 v14, 7, v11
v_mul_u32_u24 v14, 144, v14
v_lshl_add_u32 v14, v12, 3, v14
v_add3_u32 v4, v13, v14, s69
s_waitcnt vmcnt(3)
s_waitcnt lgkmcnt(14)
v_mfma_f32_32x32x16_bf16 v[160:175], v[96:99], v[128:131], v[160:175]
ds_write_b128 v7, v[176:179] offset:9216
v_mov_b32 v20, v177
v_mov_b32 v21, v178
v_mov_b32 v22, v179
ds_write_b32 v8, v176 offset:9772
s_waitcnt lgkmcnt(14)
v_mfma_f32_32x32x16_bf16 v[160:175], v[100:103], v[132:135], v[160:175]
ds_write_b96 v7, v[20:22] offset:9856
s_waitcnt vmcnt(2)
ds_write_b128 v7, v[180:183] offset:11520
v_mov_b32 v24, v181
v_mov_b32 v25, v182
s_waitcnt lgkmcnt(14)
v_mfma_f32_32x32x16_bf16 v[160:175], v[104:107], v[136:139], v[160:175]
v_mov_b32 v26, v183
ds_write_b32 v8, v180 offset:12076
ds_write_b96 v7, v[24:26] offset:12160
s_waitcnt vmcnt(1)
ds_write_b128 v7, v[184:187] offset:13824
s_waitcnt lgkmcnt(14)
v_mfma_f32_32x32x16_bf16 v[160:175], v[108:111], v[140:143], v[160:175]
v_mov_b32 v28, v185
v_mov_b32 v29, v186
v_mov_b32 v30, v187
ds_write_b32 v8, v184 offset:14380
ds_write_b96 v7, v[28:30] offset:14464
s_waitcnt lgkmcnt(14)
v_mfma_f32_32x32x16_bf16 v[160:175], v[112:115], v[144:147], v[160:175]
s_waitcnt vmcnt(0)
ds_write_b128 v7, v[188:191] offset:16128
v_mov_b32 v32, v189
v_mov_b32 v33, v190
v_mov_b32 v34, v191
s_waitcnt lgkmcnt(14)
v_mfma_f32_32x32x16_bf16 v[160:175], v[116:119], v[148:151], v[160:175]
ds_write_b32 v8, v188 offset:16684
ds_write_b96 v7, v[32:34] offset:16768
ds_write_b32 v40, v44
ds_write_b32 v40, v44 offset:4224
s_waitcnt lgkmcnt(14)
v_mfma_f32_32x32x16_bf16 v[160:175], v[120:123], v[152:155], v[160:175]
s_waitcnt lgkmcnt(14)
v_mfma_f32_32x32x16_bf16 v[160:175], v[124:127], v[156:159], v[160:175]
s_nop 4
s_branch L_C_x
.p2align 3
L_C_k0:
v_mul_f32 v22, s14, v22
v_mul_f32 v23, s14, v23
v_mul_f32 v24, s14, v24
v_mul_f32 v25, s14, v25
v_mul_f32 v22, s70, v22
v_mul_f32 v23, 0.15915494, v23
v_mul_f32 v59, s71, v22
v_mul_f32 v61, s71, v23
v_mul_f32 v60, s72, v22
v_mul_f32 v62, s72, v23
v_exp_f32 v59, v59
v_fract_f32 v61, v61
v_exp_f32 v22, v22
v_fract_f32 v23, v23
v_exp_f32 v60, v60
v_fract_f32 v62, v62
s_waitcnt lgkmcnt(14)
v_mfma_f32_32x32x16_bf16 v[160:175], v[96:99], v[128:131], v[160:175]
v_cos_f32 v47, v61
v_mul_f32 v64, v26, v24
v_sin_f32 v48, v61
v_mul_f32 v65, v26, v25
v_cos_f32 v44, v23
s_waitcnt lgkmcnt(12)
v_mfma_f32_32x32x16_bf16 v[160:175], v[100:103], v[132:135], v[160:175]
v_mul_f32 v63, v27, v25
v_sin_f32 v45, v23
v_fmac_f32 v65, v27, v24
v_cos_f32 v50, v62
v_mul_f32 v47, v59, v47
s_waitcnt lgkmcnt(10)
v_mfma_f32_32x32x16_bf16 v[160:175], v[104:107], v[136:139], v[160:175]
v_sin_f32 v51, v62
v_mul_f32 v48, v59, v48
v_mul_f32 v44, v22, v44
v_mul_f32 v45, v22, v45
v_mul_f32 v50, v60, v50
s_waitcnt lgkmcnt(8)
v_mfma_f32_32x32x16_bf16 v[160:175], v[108:111], v[140:143], v[160:175]
v_mul_f32 v51, v60, v51
v_sub_f32 v49, 0, v48
v_sub_f32 v46, 0, v45
v_sub_f32 v52, 0, v51
v_sub_f32 v64, v64, v63
s_waitcnt lgkmcnt(6)
v_mfma_f32_32x32x16_bf16 v[160:175], v[112:115], v[144:147], v[160:175]
v_mul_f32 v80, v47, v47
v_mov_b32 v22, v28
v_mul_f32 v81, v48, v47
v_mov_b32 v23, v29
v_fmac_f32 v80, v48, v49
s_waitcnt lgkmcnt(4)
v_mfma_f32_32x32x16_bf16 v[160:175], v[116:119], v[148:151], v[160:175]
v_mov_b32 v24, v30
v_fmac_f32 v81, v47, v48
v_mov_b32 v25, v31
v_mov_b32 v26, v32
v_mov_b32 v27, v33
s_waitcnt lgkmcnt(2)
v_mfma_f32_32x32x16_bf16 v[160:175], v[120:123], v[152:155], v[160:175]
v_sub_f32 v82, 0, v81
v_mov_b32 v28, v34
v_mov_b32 v29, v35
v_mov_b32 v30, v36
v_mov_b32 v31, v37
s_waitcnt lgkmcnt(0)
v_mfma_f32_32x32x16_bf16 v[160:175], v[124:127], v[156:159], v[160:175]
v_mov_b32 v32, v38
v_mov_b32 v33, v39
s_setprio 0
s_branch L_C_k
L_C_x:
s_nop 7
v_add_f32 v160, v160, v43
v_readlane_b32 s6, v167, 32
v_mov_b32_dpp v172, v168 wave_rol:1 row_mask:0xf bank_mask:0xf
v_mov_b32_dpp v173, v170 wave_rol:1 row_mask:0xf bank_mask:0xf
v_mov_b32_dpp v174, v171 wave_rol:1 row_mask:0xf bank_mask:0xf
v_mov_b32 v175, s6
v_mov_b32_dpp v172, v160 wave_shl:1 row_mask:0xf bank_mask:0xf
v_mov_b32_dpp v173, v168 wave_shl:1 row_mask:0xf bank_mask:0xf
v_mov_b32_dpp v174, v170 wave_shl:1 row_mask:0xf bank_mask:0xf
v_mov_b32_dpp v175, v171 wave_shl:1 row_mask:0xf bank_mask:0xf
v_mov_b32_dpp v167, v172 quad_perm:[0,1,2,3] row_mask:0xc bank_mask:0xf
v_cndmask_b32 v15, v174, v170, vcc
v_cndmask_b32 v16, v175, v171, vcc
v_cvt_pk_bf16_f32 v50, v160, v161
v_cvt_pk_bf16_f32 v51, v162, v163
v_cvt_pk_bf16_f32 v52, v164, v165
v_cvt_pk_bf16_f32 v53, v166, v167
ds_write_b128 v42, v[50:53] offset:64
v_cvt_pk_bf16_f32 v55, v161, v162
v_cvt_pk_bf16_f32 v56, v163, v164
v_cvt_pk_bf16_f32 v57, v165, v166
v_cvt_pk_bf16_f32 v58, v167, v172
ds_write_b32 v42, v55 offset:4300
ds_write_b96 v42, v[56:58] offset:4304
v_cvt_pk_bf16_f32 v60, v168, v168
v_cvt_pk_bf16_f32 v61, v168, v169
v_cvt_pk_bf16_f32 v62, v169, v169
v_cvt_pk_bf16_f32 v63, v173, v173
ds_write_b128 v42, v[60:63] offset:1088
v_cvt_pk_bf16_f32 v65, v168, v168
v_cvt_pk_bf16_f32 v66, v169, v169
v_cvt_pk_bf16_f32 v67, v169, v173
v_cvt_pk_bf16_f32 v68, v173, v173
ds_write_b32 v42, v65 offset:5324
ds_write_b96 v42, v[66:68] offset:5328
v_cvt_pk_bf16_f32 v50, v170, v170
v_cvt_pk_bf16_f32 v51, v170, v170
v_cvt_pk_bf16_f32 v52, v15, v174
v_cvt_pk_bf16_f32 v53, v174, v174
ds_write_b128 v42, v[50:53] offset:2112
v_cvt_pk_bf16_f32 v55, v170, v170
v_cvt_pk_bf16_f32 v56, v170, v15
v_cvt_pk_bf16_f32 v57, v174, v174
v_cvt_pk_bf16_f32 v58, v174, v174
ds_write_b32 v42, v55 offset:6348
ds_write_b96 v42, v[56:58] offset:6352
v_cvt_pk_bf16_f32 v60, v171, v16
ds_write_b32 v42, v60 offset:7376
v_cvt_pk_bf16_f32 v17, 0, v160
s_mov_b64 exec, 1
ds_write_b32 v42, v17 offset:4296
s_mov_b64 exec, -1
s_waitcnt lgkmcnt(0)
s_barrier
s_setprio 2
.p2align 3
ds_read_b64 v[64:65], v2 offset:128
ds_read_b64 v[66:67], v2 offset:160
ds_read_b64 v[96:97], v4 offset:8352
ds_read_b64 v[98:99], v4 offset:8384
ds_read_b64 v[100:101], v4 offset:7200
ds_read_b64 v[102:103], v4 offset:7232
ds_read_b64 v[104:105], v4 offset:6048
ds_read_b64 v[106:107], v4 offset:6080
ds_read_b64 v[108:109], v4 offset:4896
ds_read_b64 v[110:111], v4 offset:4928
ds_read_b64 v[112:113], v4 offset:3744
ds_read_b64 v[114:115], v4 offset:3776
ds_read_b64 v[116:117], v4 offset:2592
ds_read_b64 v[118:119], v4 offset:2624
ds_read_b64 v[120:121], v4 offset:1440
ds_read_b64 v[122:123], v4 offset:1472
s_waitcnt lgkmcnt(6)
s_nop 0
ds_read_b64 v[124:125], v4 offset:288
ds_read_b64 v[126:127], v4 offset:320
ds_read_b64 v[68:69], v2 offset:640
ds_read_b64 v[70:71], v2 offset:672
ds_read_b64 v[72:73], v2 offset:1152
ds_read_b64 v[74:75], v2 offset:1184
ds_read_b64 v[76:77], v2 offset:1664
ds_read_b64 v[78:79], v2 offset:1696
s_waitcnt lgkmcnt(6)
s_nop 0
s_mul_i32 s13, s5, 20544
v_lshlrev_b32 v13, 5, v11
v_lshl_add_u32 v13, v12, 3, v13
v_lshl_add_u32 v13, v10, 2, v13
v_add_u32 v13, s13, v13
v_bfe_u32 v14, v1, 2, 2
v_mul_u32_u24 v14, 20544, v14
v_lshl_add_u32 v14, v12, 5, v14
v_and_b32 v15, 3, v1
v_lshl_add_u32 v14, v15, 3, v14
s_lshl_b32 s13, s5, 9
v_add_u32 v14, s13, v14
v_and_b32 v15, 60, v1
v_bfe_u32 v16, v1, 1, 1
v_lshl_add_u32 v16, v10, 1, v16
v_add_u32 v15, v15, v16
v_lshlrev_b32 v15, 4, v15
s_lshl_b32 s13, s5, 12
s_add_u32 s50, s50, s13
s_add_u32 s50, s50, 11534336
s_waitcnt lgkmcnt(0)
s_nop 0
v_mfma_f32_16x16x32_bf16 v[192:195], v[64:67], v[96:99], 0
ds_read_b64 v[128:129], v2 offset:192
v_mfma_f32_16x16x32_bf16 v[196:199], v[64:67], v[100:103], 0
ds_read_b64 v[130:131], v2 offset:224
v_mfma_f32_16x16x32_bf16 v[200:203], v[64:67], v[104:107], 0
ds_read_b64 v[160:161], v4 offset:8496
v_mfma_f32_16x16x32_bf16 v[204:207], v[64:67], v[108:111], 0
ds_read_b64 v[162:163], v4 offset:8528
v_mfma_f32_16x16x32_bf16 v[208:211], v[64:67], v[112:115], 0
ds_read_b64 v[164:165], v4 offset:7344
v_mfma_f32_16x16x32_bf16 v[212:215], v[64:67], v[116:119], 0
ds_read_b64 v[166:167], v4 offset:7376
v_mfma_f32_16x16x32_bf16 v[216:219], v[64:67], v[120:123], 0
ds_read_b64 v[168:169], v4 offset:6192
v_mfma_f32_16x16x32_bf16 v[220:223], v[64:67], v[124:127], 0
ds_read_b64 v[170:171], v4 offset:6224
v_mfma_f32_16x16x32_bf16 v[196:199], v[68:71], v[96:99], v[196:199]
ds_read_b64 v[172:173], v4 offset:5040
v_mfma_f32_16x16x32_bf16 v[200:203], v[68:71], v[100:103], v[200:203]
ds_read_b64 v[174:175], v4 offset:5072
v_mfma_f32_16x16x32_bf16 v[204:207], v[68:71], v[104:107], v[204:207]
ds_read_b64 v[176:177], v4 offset:3888
v_mfma_f32_16x16x32_bf16 v[208:211], v[68:71], v[108:111], v[208:211]
ds_read_b64 v[178:179], v4 offset:3920
v_mfma_f32_16x16x32_bf16 v[212:215], v[68:71], v[112:115], v[212:215]
ds_read_b64 v[180:181], v4 offset:2736
v_mfma_f32_16x16x32_bf16 v[216:219], v[68:71], v[116:119], v[216:219]
ds_read_b64 v[182:183], v4 offset:2768
v_mfma_f32_16x16x32_bf16 v[220:223], v[68:71], v[120:123], v[220:223]
ds_read_b64 v[184:185], v4 offset:1584
v_mfma_f32_16x16x32_bf16 v[200:203], v[72:75], v[96:99], v[200:203]
ds_read_b64 v[186:187], v4 offset:1616
v_mfma_f32_16x16x32_bf16 v[204:207], v[72:75], v[100:103], v[204:207]
ds_read_b64 v[188:189], v4 offset:432
v_mfma_f32_16x16x32_bf16 v[208:211], v[72:75], v[104:107], v[208:211]
ds_read_b64 v[190:191], v4 offset:464
v_mfma_f32_16x16x32_bf16 v[212:215], v[72:75], v[108:111], v[212:215]
ds_read_b64 v[48:49], v250 offset:3456
v_mfma_f32_16x16x32_bf16 v[216:219], v[72:75], v[112:115], v[216:219]
ds_read_b64 v[50:51], v251 offset:3456
v_mfma_f32_16x16x32_bf16 v[220:223], v[72:75], v[116:119], v[220:223]
ds_read_b64 v[52:53], v250 offset:2304
v_mfma_f32_16x16x32_bf16 v[204:207], v[76:79], v[96:99], v[204:207]
ds_read_b64 v[54:55], v251 offset:2304
v_mfma_f32_16x16x32_bf16 v[208:211], v[76:79], v[100:103], v[208:211]
ds_read_b64 v[56:57], v250 offset:1152
v_mfma_f32_16x16x32_bf16 v[212:215], v[76:79], v[104:107], v[212:215]
ds_read_b64 v[58:59], v251 offset:1152
v_mfma_f32_16x16x32_bf16 v[216:219], v[76:79], v[108:111], v[216:219]
ds_read_b64 v[60:61], v250 offset:0
v_mfma_f32_16x16x32_bf16 v[220:223], v[76:79], v[112:115], v[220:223]
ds_read_b64 v[62:63], v251 offset:0
s_waitcnt lgkmcnt(5)
s_nop 0
v_mfma_f32_16x16x32_bf16 v[192:195], v[128:131], v[160:163], v[192:195]
ds_read_b64 v[132:133], v2 offset:704
v_mfma_f32_16x16x32_bf16 v[196:199], v[128:131], v[164:167], v[196:199]
ds_read_b64 v[134:135], v2 offset:736
v_mfma_f32_16x16x32_bf16 v[200:203], v[128:131], v[168:171], v[200:203]
ds_read_b64 v[136:137], v2 offset:1216
v_mfma_f32_16x16x32_bf16 v[204:207], v[128:131], v[172:175], v[204:207]
ds_read_b64 v[138:139], v2 offset:1248
v_mfma_f32_16x16x32_bf16 v[208:211], v[128:131], v[176:179], v[208:211]
ds_read_b64 v[140:141], v2 offset:1728
v_mfma_f32_16x16x32_bf16 v[20:23], v[48:51], v[240:243], 0
ds_read_b64 v[142:143], v2 offset:1760
v_mfma_f32_16x16x32_bf16 v[212:215], v[128:131], v[180:183], v[212:215]
ds_read_b64 v[64:65], v2 offset:256
v_mfma_f32_16x16x32_bf16 v[24:27], v[48:51], v[244:247], 0
ds_read_b64 v[66:67], v2 offset:288
v_mfma_f32_16x16x32_bf16 v[216:219], v[128:131], v[184:187], v[216:219]
ds_read_b64 v[96:97], v4 offset:8640
s_waitcnt lgkmcnt(5)
s_nop 0
v_mfma_f32_16x16x32_bf16 v[28:31], v[52:55], v[240:243], 0
ds_read_b64 v[98:99], v4 offset:8672
v_mfma_f32_16x16x32_bf16 v[220:223], v[128:131], v[188:191], v[220:223]
ds_read_b64 v[100:101], v4 offset:7488
v_mfma_f32_16x16x32_bf16 v[32:35], v[52:55], v[244:247], 0
ds_read_b64 v[102:103], v4 offset:7520
v_mfma_f32_16x16x32_bf16 v[196:199], v[132:135], v[160:163], v[196:199]
ds_read_b64 v[104:105], v4 offset:6336
v_mfma_f32_16x16x32_bf16 v[84:87], v[56:59], v[240:243], 0
ds_read_b64 v[106:107], v4 offset:6368
v_mfma_f32_16x16x32_bf16 v[200:203], v[132:135], v[164:167], v[200:203]
ds_read_b64 v[108:109], v4 offset:5184
v_mfma_f32_16x16x32_bf16 v[88:91], v[56:59], v[244:247], 0
ds_read_b64 v[110:111], v4 offset:5216
v_mfma_f32_16x16x32_bf16 v[204:207], v[132:135], v[168:171], v[204:207]
ds_read_b64 v[112:113], v4 offset:4032
v_mfma_f32_16x16x32_bf16 v[148:151], v[60:63], v[240:243], 0
ds_read_b64 v[114:115], v4 offset:4064
v_mfma_f32_16x16x32_bf16 v[208:211], v[132:135], v[172:175], v[208:211]
ds_read_b64 v[116:117], v4 offset:2880
v_mfma_f32_16x16x32_bf16 v[152:155], v[60:63], v[244:247], 0
ds_read_b64 v[118:119], v4 offset:2912
v_mfma_f32_16x16x32_bf16 v[212:215], v[132:135], v[176:179], v[212:215]
ds_read_b64 v[120:121], v4 offset:1728
v_mfma_f32_16x16x32_bf16 v[216:219], v[132:135], v[180:183], v[216:219]
ds_read_b64 v[122:123], v4 offset:1760
v_mfma_f32_16x16x32_bf16 v[220:223], v[132:135], v[184:187], v[220:223]
ds_read_b64 v[124:125], v4 offset:576
v_mfma_f32_16x16x32_bf16 v[200:203], v[136:139], v[160:163], v[200:203]
ds_read_b64 v[126:127], v4 offset:608
v_mfma_f32_16x16x32_bf16 v[204:207], v[136:139], v[164:167], v[204:207]
ds_read2_b32 v[224:225], v94 offset0:24 offset1:16
v_mfma_f32_16x16x32_bf16 v[208:211], v[136:139], v[168:171], v[208:211]
v_mfma_f32_16x16x32_bf16 v[212:215], v[136:139], v[172:175], v[212:215]
ds_read2_b32 v[226:227], v94 offset0:8 offset1:0
v_mfma_f32_16x16x32_bf16 v[216:219], v[136:139], v[176:179], v[216:219]
v_mfma_f32_16x16x32_bf16 v[220:223], v[136:139], v[180:183], v[220:223]
ds_read2_b32 v[228:229], v94 offset0:152 offset1:144
s_waitcnt lgkmcnt(5)
s_nop 0
v_mfma_f32_16x16x32_bf16 v[204:207], v[140:143], v[160:163], v[204:207]
v_mfma_f32_16x16x32_bf16 v[208:211], v[140:143], v[164:167], v[208:211]
ds_read2_b32 v[230:231], v94 offset0:136 offset1:128
v_mfma_f32_16x16x32_bf16 v[212:215], v[140:143], v[168:171], v[212:215]
v_mfma_f32_16x16x32_bf16 v[216:219], v[140:143], v[172:175], v[216:219]
ds_write_b16 v249, v248 offset:2122
v_mfma_f32_16x16x32_bf16 v[220:223], v[140:143], v[176:179], v[220:223]
ds_write_b16 v249, v248 offset:6356
v_mfma_f32_16x16x32_bf16 v[192:195], v[64:67], v[96:99], v[192:195]
ds_read_b64 v[68:69], v2 offset:768
v_mfma_f32_16x16x32_bf16 v[196:199], v[64:67], v[100:103], v[196:199]
ds_read_b64 v[70:71], v2 offset:800
v_mfma_f32_16x16x32_bf16 v[200:203], v[64:67], v[104:107], v[200:203]
ds_read_b64 v[72:73], v2 offset:1280
v_mfma_f32_16x16x32_bf16 v[204:207], v[64:67], v[108:111], v[204:207]
ds_read_b64 v[74:75], v2 offset:1312
v_mfma_f32_16x16x32_bf16 v[208:211], v[64:67], v[112:115], v[208:211]
ds_read_b64 v[76:77], v2 offset:1792
v_mfma_f32_16x16x32_bf16 v[212:215], v[64:67], v[116:119], v[212:215]
ds_read_b64 v[78:79], v2 offset:1824
v_mfma_f32_16x16x32_bf16 v[216:219], v[64:67], v[120:123], v[216:219]
v_cvt_pk_bf16_f32 v48, v20, v24
v_cvt_pk_bf16_f32 v49, v21, v25
v_cvt_pk_bf16_f32 v50, v22, v26
v_cvt_pk_bf16_f32 v51, v23, v27
v_cvt_pk_bf16_f32 v52, v28, v32
v_cvt_pk_bf16_f32 v53, v29, v33
v_cvt_pk_bf16_f32 v54, v30, v34
v_cvt_pk_bf16_f32 v55, v31, v35
v_cvt_pk_bf16_f32 v56, v84, v88
v_cvt_pk_bf16_f32 v57, v85, v89
v_cvt_pk_bf16_f32 v58, v86, v90
v_cvt_pk_bf16_f32 v59, v87, v91
v_cvt_pk_bf16_f32 v60, v148, v152
v_cvt_pk_bf16_f32 v61, v149, v153
v_cvt_pk_bf16_f32 v62, v150, v154
v_cvt_pk_bf16_f32 v63, v151, v155
s_waitcnt lgkmcnt(5)
s_nop 0
v_cndmask_b32_e64 v224, 0, v224, s[40:41]
v_cndmask_b32_e64 v225, 0, v225, s[42:43]
v_cndmask_b32_e64 v226, 0, v226, s[44:45]
v_cndmask_b32_e64 v227, 0, v227, s[46:47]
ds_read_b64 v[128:129], v2 offset:64
v_mfma_f32_16x16x32_bf16 v[220:223], v[64:67], v[124:127], v[220:223]
ds_read_b64 v[130:131], v2 offset:96
s_waitcnt lgkmcnt(5)
s_nop 0
v_mfma_f32_16x16x32_bf16 v[196:199], v[68:71], v[96:99], v[196:199]
ds_read_b64 v[160:161], v4 offset:8208
v_mfma_f32_16x16x32_bf16 v[200:203], v[68:71], v[100:103], v[200:203]
ds_read_b64 v[162:163], v4 offset:8240
v_mfma_f32_16x16x32_bf16 v[204:207], v[68:71], v[104:107], v[204:207]
ds_read_b64 v[164:165], v4 offset:7056
v_mfma_f32_16x16x32_bf16 v[208:211], v[68:71], v[108:111], v[208:211]
ds_read_b64 v[166:167], v4 offset:7088
v_mfma_f32_16x16x32_bf16 v[212:215], v[68:71], v[112:115], v[212:215]
ds_read_b64 v[168:169], v4 offset:5904
v_mfma_f32_16x16x32_bf16 v[216:219], v[68:71], v[116:119], v[216:219]
ds_read_b64 v[170:171], v4 offset:5936
v_mfma_f32_16x16x32_bf16 v[220:223], v[68:71], v[120:123], v[220:223]
ds_read_b64 v[172:173], v4 offset:4752
s_waitcnt lgkmcnt(5)
s_nop 0
v_mfma_f32_16x16x32_bf16 v[200:203], v[72:75], v[96:99], v[200:203]
ds_read_b64 v[174:175], v4 offset:4784
v_mfma_f32_16x16x32_bf16 v[204:207], v[72:75], v[100:103], v[204:207]
ds_read_b64 v[176:177], v4 offset:3600
v_mfma_f32_16x16x32_bf16 v[208:211], v[72:75], v[104:107], v[208:211]
ds_read_b64 v[178:179], v4 offset:3632
v_mfma_f32_16x16x32_bf16 v[212:215], v[72:75], v[108:111], v[212:215]
ds_read_b64 v[180:181], v4 offset:2448
v_mfma_f32_16x16x32_bf16 v[216:219], v[72:75], v[112:115], v[216:219]
ds_read_b64 v[182:183], v4 offset:2480
v_mfma_f32_16x16x32_bf16 v[220:223], v[72:75], v[116:119], v[220:223]
ds_read_b64 v[184:185], v4 offset:1296
v_mfma_f32_16x16x32_bf16 v[204:207], v[76:79], v[96:99], v[204:207]
ds_read_b64 v[186:187], v4 offset:1328
v_mfma_f32_16x16x32_bf16 v[208:211], v[76:79], v[100:103], v[208:211]
ds_read_b64 v[188:189], v4 offset:144
v_mfma_f32_16x16x32_bf16 v[212:215], v[76:79], v[104:107], v[212:215]
ds_read_b64 v[190:191], v4 offset:176
v_mfma_f32_16x16x32_bf16 v[216:219], v[76:79], v[108:111], v[216:219]
ds_read_b64 v[132:133], v2 offset:576
v_mfma_f32_16x16x32_bf16 v[220:223], v[76:79], v[112:115], v[220:223]
ds_read_b64 v[134:135], v2 offset:608
v_mfma_f32_16x16x32_bf16 v[192:195], v[128:131], v[160:163], v[192:195]
ds_read_b64 v[136:137], v2 offset:1088
s_waitcnt lgkmcnt(5)
s_nop 0
v_mfma_f32_16x16x32_bf16 v[196:199], v[128:131], v[164:167], v[196:199]
ds_read_b64 v[138:139], v2 offset:1120
v_mfma_f32_16x16x32_bf16 v[200:203], v[128:131], v[168:171], v[200:203]
ds_read_b64 v[140:141], v2 offset:1600
v_mfma_f32_16x16x32_bf16 v[204:207], v[128:131], v[172:175], v[204:207]
ds_read_b64 v[142:143], v2 offset:1632
v_mfma_f32_16x16x32_bf16 v[208:211], v[128:131], v[176:179], v[208:211]
ds_read_b64 v[144:145], v2 offset:2112
v_mfma_f32_16x16x32_bf16 v[212:215], v[128:131], v[180:183], v[212:215]
ds_read_b64 v[146:147], v2 offset:2144
v_mfma_f32_16x16x32_bf16 v[216:219], v[128:131], v[184:187], v[216:219]
ds_read2_b32 v[232:233], v95 offset0:24 offset1:16
s_waitcnt lgkmcnt(5)
s_nop 0
v_mfma_f32_16x16x32_bf16 v[220:223], v[128:131], v[188:191], v[220:223]
v_mfma_f32_16x16x32_bf16 v[196:199], v[132:135], v[160:163], v[196:199]
ds_read2_b32 v[234:235], v95 offset0:8 offset1:0
v_mfma_f32_16x16x32_bf16 v[200:203], v[132:135], v[164:167], v[200:203]
v_mfma_f32_16x16x32_bf16 v[204:207], v[132:135], v[168:171], v[204:207]
ds_read2_b32 v[236:237], v95 offset0:152 offset1:144
v_mfma_f32_16x16x32_bf16 v[208:211], v[132:135], v[172:175], v[208:211]
v_mfma_f32_16x16x32_bf16 v[212:215], v[132:135], v[176:179], v[212:215]
ds_read2_b32 v[238:239], v95 offset0:136 offset1:128
v_mfma_f32_16x16x32_bf16 v[20:23], v[48:51], v[224:227], 0
v_mfma_f32_16x16x32_bf16 v[216:219], v[132:135], v[180:183], v[216:219]
ds_read_b64 v[64:65], v2 offset:0
v_mfma_f32_16x16x32_bf16 v[24:27], v[52:55], v[224:227], 0
ds_read_b64 v[66:67], v2 offset:32
v_mfma_f32_16x16x32_bf16 v[220:223], v[132:135], v[184:187], v[220:223]
ds_read_b64 v[96:97], v4 offset:8064
v_mfma_f32_16x16x32_bf16 v[28:31], v[56:59], v[224:227], 0
ds_read_b64 v[98:99], v4 offset:8096
v_mfma_f32_16x16x32_bf16 v[200:203], v[136:139], v[160:163], v[200:203]
ds_read_b64 v[100:101], v4 offset:6912
v_mfma_f32_16x16x32_bf16 v[32:35], v[60:63], v[224:227], 0
ds_read_b64 v[102:103], v4 offset:6944
v_mfma_f32_16x16x32_bf16 v[204:207], v[136:139], v[164:167], v[204:207]
ds_read_b64 v[104:105], v4 offset:5760
v_mfma_f32_16x16x32_bf16 v[24:27], v[48:51], v[228:231], v[24:27]
ds_read_b64 v[106:107], v4 offset:5792
v_mfma_f32_16x16x32_bf16 v[208:211], v[136:139], v[168:171], v[208:211]
ds_read_b64 v[108:109], v4 offset:4608
v_mfma_f32_16x16x32_bf16 v[28:31], v[52:55], v[228:231], v[28:31]
ds_read_b64 v[110:111], v4 offset:4640
v_mfma_f32_16x16x32_bf16 v[212:215], v[136:139], v[172:175], v[212:215]
ds_read_b64 v[112:113], v4 offset:3456
v_mfma_f32_16x16x32_bf16 v[32:35], v[56:59], v[228:231], v[32:35]
ds_read_b64 v[114:115], v4 offset:3488
v_mfma_f32_16x16x32_bf16 v[216:219], v[136:139], v[176:179], v[216:219]
ds_read_b64 v[116:117], v4 offset:2304
s_waitcnt lgkmcnt(5)
s_nop 0
v_mfma_f32_16x16x32_bf16 v[28:31], v[48:51], v[232:235], v[28:31]
ds_read_b64 v[118:119], v4 offset:2336
v_mfma_f32_16x16x32_bf16 v[220:223], v[136:139], v[180:183], v[220:223]
ds_read_b64 v[120:121], v4 offset:1152
v_mfma_f32_16x16x32_bf16 v[32:35], v[52:55], v[232:235], v[32:35]
ds_read_b64 v[122:123], v4 offset:1184
v_mfma_f32_16x16x32_bf16 v[204:207], v[140:143], v[160:163], v[204:207]
ds_read_b64 v[124:125], v4 offset:0
v_mfma_f32_16x16x32_bf16 v[32:35], v[48:51], v[236:239], v[32:35]
ds_read_b64 v[126:127], v4 offset:32
v_mfma_f32_16x16x32_bf16 v[208:211], v[140:143], v[164:167], v[208:211]
ds_read_b64 v[68:69], v2 offset:512
v_mfma_f32_16x16x32_bf16 v[212:215], v[140:143], v[168:171], v[212:215]
ds_read_b64 v[70:71], v2 offset:544
v_mfma_f32_16x16x32_bf16 v[216:219], v[140:143], v[172:175], v[216:219]
ds_read_b64 v[72:73], v2 offset:1024
v_mfma_f32_16x16x32_bf16 v[220:223], v[140:143], v[176:179], v[220:223]
ds_read_b64 v[74:75], v2 offset:1056
v_mfma_f32_16x16x32_bf16 v[208:211], v[144:147], v[160:163], v[208:211]
ds_read_b64 v[76:77], v2 offset:1536
v_mfma_f32_16x16x32_bf16 v[212:215], v[144:147], v[164:167], v[212:215]
ds_read_b64 v[78:79], v2 offset:1568
v_mfma_f32_16x16x32_bf16 v[216:219], v[144:147], v[168:171], v[216:219]
ds_read_b64 v[80:81], v2 offset:2048
v_mfma_f32_16x16x32_bf16 v[220:223], v[144:147], v[172:175], v[220:223]
ds_read_b64 v[82:83], v2 offset:2080
v_mfma_f32_16x16x32_bf16 v[192:195], v[64:67], v[96:99], v[192:195]
ds_read_b64 v[128:129], v2 offset:320
v_mfma_f32_16x16x32_bf16 v[196:199], v[64:67], v[100:103], v[196:199]
ds_read_b64 v[130:131], v2 offset:352
v_mfma_f32_16x16x32_bf16 v[200:203], v[64:67], v[104:107], v[200:203]
ds_read_b64 v[160:161], v4 offset:8784
s_waitcnt lgkmcnt(5)
s_nop 0
v_mfma_f32_16x16x32_bf16 v[204:207], v[64:67], v[108:111], v[204:207]
ds_read_b64 v[162:163], v4 offset:8816
v_mfma_f32_16x16x32_bf16 v[208:211], v[64:67], v[112:115], v[208:211]
ds_read_b64 v[164:165], v4 offset:7632
v_mfma_f32_16x16x32_bf16 v[212:215], v[64:67], v[116:119], v[212:215]
ds_read_b64 v[166:167], v4 offset:7664
v_mfma_f32_16x16x32_bf16 v[216:219], v[64:67], v[120:123], v[216:219]
ds_read_b64 v[168:169], v4 offset:6480
v_mfma_f32_16x16x32_bf16 v[220:223], v[64:67], v[124:127], v[220:223]
ds_read_b64 v[170:171], v4 offset:6512
v_mfma_f32_16x16x32_bf16 v[196:199], v[68:71], v[96:99], v[196:199]
ds_read_b64 v[172:173], v4 offset:5328
v_mfma_f32_16x16x32_bf16 v[200:203], v[68:71], v[100:103], v[200:203]
ds_read_b64 v[174:175], v4 offset:5360
v_mfma_f32_16x16x32_bf16 v[204:207], v[68:71], v[104:107], v[204:207]
ds_read_b64 v[176:177], v4 offset:4176
v_mfma_f32_16x16x32_bf16 v[208:211], v[68:71], v[108:111], v[208:211]
ds_read_b64 v[178:179], v4 offset:4208
v_mfma_f32_16x16x32_bf16 v[212:215], v[68:71], v[112:115], v[212:215]
ds_read_b64 v[180:181], v4 offset:3024
v_mfma_f32_16x16x32_bf16 v[216:219], v[68:71], v[116:119], v[216:219]
ds_read_b64 v[182:183], v4 offset:3056
v_mfma_f32_16x16x32_bf16 v[220:223], v[68:71], v[120:123], v[220:223]
ds_read_b64 v[184:185], v4 offset:1872
v_mfma_f32_16x16x32_bf16 v[200:203], v[72:75], v[96:99], v[200:203]
ds_read_b64 v[186:187], v4 offset:1904
v_mfma_f32_16x16x32_bf16 v[204:207], v[72:75], v[100:103], v[204:207]
ds_read_b64 v[188:189], v4 offset:720
v_mfma_f32_16x16x32_bf16 v[208:211], v[72:75], v[104:107], v[208:211]
ds_read_b64 v[190:191], v4 offset:752
v_mfma_f32_16x16x32_bf16 v[212:215], v[72:75], v[108:111], v[212:215]
ds_write_b128 v252, v[20:23] offset:2176
v_mfma_f32_16x16x32_bf16 v[216:219], v[72:75], v[112:115], v[216:219]
v_mfma_f32_16x16x32_bf16 v[220:223], v[72:75], v[116:119], v[220:223]
ds_write_b128 v252, v[24:27] offset:3200
v_mfma_f32_16x16x32_bf16 v[204:207], v[76:79], v[96:99], v[204:207]
v_mfma_f32_16x16x32_bf16 v[208:211], v[76:79], v[100:103], v[208:211]
ds_write_b128 v252, v[28:31] offset:6400
v_mfma_f32_16x16x32_bf16 v[212:215], v[76:79], v[104:107], v[212:215]
v_mfma_f32_16x16x32_bf16 v[216:219], v[76:79], v[108:111], v[216:219]
ds_write_b128 v252, v[32:35] offset:7424
v_mfma_f32_16x16x32_bf16 v[220:223], v[76:79], v[112:115], v[220:223]
s_waitcnt lgkmcnt(5)
s_nop 0
v_mfma_f32_16x16x32_bf16 v[208:211], v[80:83], v[96:99], v[208:211]
ds_read_b64 v[132:133], v2 offset:832
v_mfma_f32_16x16x32_bf16 v[212:215], v[80:83], v[100:103], v[212:215]
ds_read_b64 v[134:135], v2 offset:864
v_mfma_f32_16x16x32_bf16 v[216:219], v[80:83], v[104:107], v[216:219]
ds_read_b64 v[136:137], v2 offset:1344
v_mfma_f32_16x16x32_bf16 v[220:223], v[80:83], v[108:111], v[220:223]
ds_read_b64 v[138:139], v2 offset:1376
v_mfma_f32_16x16x32_bf16 v[192:195], v[128:131], v[160:163], v[192:195]
ds_read_b64 v[140:141], v2 offset:1856
v_mfma_f32_16x16x32_bf16 v[196:199], v[128:131], v[164:167], v[196:199]
ds_read_b64 v[142:143], v2 offset:1888
v_mfma_f32_16x16x32_bf16 v[200:203], v[128:131], v[168:171], v[200:203]
ds_read_b64 v[64:65], v2 offset:384
v_mfma_f32_16x16x32_bf16 v[204:207], v[128:131], v[172:175], v[204:207]
ds_read_b64 v[66:67], v2 offset:416
v_mfma_f32_16x16x32_bf16 v[208:211], v[128:131], v[176:179], v[208:211]
ds_read_b64 v[96:97], v4 offset:8928
v_mfma_f32_16x16x32_bf16 v[212:215], v[128:131], v[180:183], v[212:215]
ds_read_b64 v[98:99], v4 offset:8960
v_mfma_f32_16x16x32_bf16 v[216:219], v[128:131], v[184:187], v[216:219]
ds_read_b64 v[100:101], v4 offset:7776
s_waitcnt lgkmcnt(5)
s_nop 0
v_mfma_f32_16x16x32_bf16 v[220:223], v[128:131], v[188:191], v[220:223]
ds_read_b64 v[102:103], v4 offset:7808
v_mfma_f32_16x16x32_bf16 v[196:199], v[132:135], v[160:163], v[196:199]
ds_read_b64 v[104:105], v4 offset:6624
v_mfma_f32_16x16x32_bf16 v[200:203], v[132:135], v[164:167], v[200:203]
ds_read_b64 v[106:107], v4 offset:6656
v_mfma_f32_16x16x32_bf16 v[204:207], v[132:135], v[168:171], v[204:207]
ds_read_b64 v[108:109], v4 offset:5472
v_mfma_f32_16x16x32_bf16 v[208:211], v[132:135], v[172:175], v[208:211]
ds_read_b64 v[110:111], v4 offset:5504
v_mfma_f32_16x16x32_bf16 v[212:215], v[132:135], v[176:179], v[212:215]
ds_read_b64 v[112:113], v4 offset:4320
v_mfma_f32_16x16x32_bf16 v[216:219], v[132:135], v[180:183], v[216:219]
ds_read_b64 v[114:115], v4 offset:4352
v_mfma_f32_16x16x32_bf16 v[220:223], v[132:135], v[184:187], v[220:223]
ds_read_b64 v[116:117], v4 offset:3168
v_mfma_f32_16x16x32_bf16 v[200:203], v[136:139], v[160:163], v[200:203]
ds_read_b64 v[118:119], v4 offset:3200
v_mfma_f32_16x16x32_bf16 v[204:207], v[136:139], v[164:167], v[204:207]
ds_read_b64 v[120:121], v4 offset:2016
v_mfma_f32_16x16x32_bf16 v[208:211], v[136:139], v[168:171], v[208:211]
ds_read_b64 v[122:123], v4 offset:2048
v_mfma_f32_16x16x32_bf16 v[212:215], v[136:139], v[172:175], v[212:215]
ds_read_b64 v[124:125], v4 offset:864
v_mfma_f32_16x16x32_bf16 v[216:219], v[136:139], v[176:179], v[216:219]
ds_read_b64 v[126:127], v4 offset:896
v_mfma_f32_16x16x32_bf16 v[220:223], v[136:139], v[180:183], v[220:223]
ds_read_b64 v[68:69], v2 offset:896
v_mfma_f32_16x16x32_bf16 v[204:207], v[140:143], v[160:163], v[204:207]
ds_read_b64 v[70:71], v2 offset:928
v_mfma_f32_16x16x32_bf16 v[208:211], v[140:143], v[164:167], v[208:211]
ds_read_b64 v[72:73], v2 offset:1408
v_mfma_f32_16x16x32_bf16 v[212:215], v[140:143], v[168:171], v[212:215]
ds_read_b64 v[74:75], v2 offset:1440
v_mfma_f32_16x16x32_bf16 v[216:219], v[140:143], v[172:175], v[216:219]
ds_read_b64 v[76:77], v2 offset:1920
v_mfma_f32_16x16x32_bf16 v[220:223], v[140:143], v[176:179], v[220:223]
ds_read_b64 v[78:79], v2 offset:1952
s_waitcnt lgkmcnt(5)
s_nop 0
v_mfma_f32_16x16x32_bf16 v[192:195], v[64:67], v[96:99], v[192:195]
ds_read_b64 v[128:129], v2 offset:448
v_mfma_f32_16x16x32_bf16 v[196:199], v[64:67], v[100:103], v[196:199]
ds_read_b64 v[130:131], v2 offset:480
v_mfma_f32_16x16x32_bf16 v[200:203], v[64:67], v[104:107], v[200:203]
ds_read_b64 v[160:161], v4 offset:9072
v_mfma_f32_16x16x32_bf16 v[204:207], v[64:67], v[108:111], v[204:207]
ds_read_b64 v[162:163], v4 offset:9104
v_mfma_f32_16x16x32_bf16 v[208:211], v[64:67], v[112:115], v[208:211]
ds_read_b64 v[164:165], v4 offset:7920
v_mfma_f32_16x16x32_bf16 v[212:215], v[64:67], v[116:119], v[212:215]
ds_read_b64 v[166:167], v4 offset:7952
v_mfma_f32_16x16x32_bf16 v[216:219], v[64:67], v[120:123], v[216:219]
ds_read_b64 v[168:169], v4 offset:6768
v_mfma_f32_16x16x32_bf16 v[220:223], v[64:67], v[124:127], v[220:223]
ds_read_b64 v[170:171], v4 offset:6800
s_waitcnt lgkmcnt(5)
s_nop 0
v_mfma_f32_16x16x32_bf16 v[196:199], v[68:71], v[96:99], v[196:199]
ds_read_b64 v[172:173], v4 offset:5616
v_mfma_f32_16x16x32_bf16 v[200:203], v[68:71], v[100:103], v[200:203]
ds_read_b64 v[174:175], v4 offset:5648
v_mfma_f32_16x16x32_bf16 v[204:207], v[68:71], v[104:107], v[204:207]
ds_read_b64 v[176:177], v4 offset:4464
v_mfma_f32_16x16x32_bf16 v[208:211], v[68:71], v[108:111], v[208:211]
ds_read_b64 v[178:179], v4 offset:4496
v_mfma_f32_16x16x32_bf16 v[212:215], v[68:71], v[112:115], v[212:215]
ds_read_b64 v[180:181], v4 offset:3312
v_mfma_f32_16x16x32_bf16 v[216:219], v[68:71], v[116:119], v[216:219]
ds_read_b64 v[182:183], v4 offset:3344
v_mfma_f32_16x16x32_bf16 v[220:223], v[68:71], v[120:123], v[220:223]
ds_read_b64 v[184:185], v4 offset:2160
v_mfma_f32_16x16x32_bf16 v[200:203], v[72:75], v[96:99], v[200:203]
ds_read_b64 v[186:187], v4 offset:2192
v_mfma_f32_16x16x32_bf16 v[204:207], v[72:75], v[100:103], v[204:207]
ds_read_b64 v[188:189], v4 offset:1008
v_mfma_f32_16x16x32_bf16 v[208:211], v[72:75], v[104:107], v[208:211]
ds_read_b64 v[190:191], v4 offset:1040
v_mfma_f32_16x16x32_bf16 v[212:215], v[72:75], v[108:111], v[212:215]
ds_read_b64 v[132:133], v2 offset:960
v_mfma_f32_16x16x32_bf16 v[216:219], v[72:75], v[112:115], v[216:219]
ds_read_b64 v[134:135], v2 offset:992
v_mfma_f32_16x16x32_bf16 v[220:223], v[72:75], v[116:119], v[220:223]
ds_read_b64 v[136:137], v2 offset:1472
v_mfma_f32_16x16x32_bf16 v[204:207], v[76:79], v[96:99], v[204:207]
ds_read_b64 v[138:139], v2 offset:1504
v_mfma_f32_16x16x32_bf16 v[208:211], v[76:79], v[100:103], v[208:211]
ds_read_b64 v[140:141], v2 offset:1984
v_mfma_f32_16x16x32_bf16 v[212:215], v[76:79], v[104:107], v[212:215]
ds_read_b64 v[142:143], v2 offset:2016
v_mfma_f32_16x16x32_bf16 v[216:219], v[76:79], v[108:111], v[216:219]
v_mfma_f32_16x16x32_bf16 v[220:223], v[76:79], v[112:115], v[220:223]
s_waitcnt lgkmcnt(5)
s_nop 0
v_mfma_f32_16x16x32_bf16 v[208:211], v[128:131], v[176:179], v[208:211]
ds_read_b64 v[224:225], v92 offset:2176
v_mfma_f32_16x16x32_bf16 v[212:215], v[128:131], v[180:183], v[212:215]
ds_read_b64 v[226:227], v93 offset:2176
v_mfma_f32_16x16x32_bf16 v[216:219], v[128:131], v[184:187], v[216:219]
ds_read_b64 v[228:229], v92 offset:3200
v_mfma_f32_16x16x32_bf16 v[220:223], v[128:131], v[188:191], v[220:223]
ds_read_b64 v[230:231], v93 offset:3200
s_waitcnt lgkmcnt(5)
s_nop 0
v_mfma_f32_16x16x32_bf16 v[208:211], v[132:135], v[172:175], v[208:211]
ds_read_b64 v[232:233], v92 offset:6400
v_mfma_f32_16x16x32_bf16 v[212:215], v[132:135], v[176:179], v[212:215]
ds_read_b64 v[234:235], v93 offset:6400
v_mfma_f32_16x16x32_bf16 v[216:219], v[132:135], v[180:183], v[216:219]
ds_read_b64 v[236:237], v92 offset:7424
v_mfma_f32_16x16x32_bf16 v[220:223], v[132:135], v[184:187], v[220:223]
ds_read_b64 v[238:239], v93 offset:7424
v_mfma_f32_16x16x32_bf16 v[208:211], v[136:139], v[168:171], v[208:211]
v_mfma_f32_16x16x32_bf16 v[212:215], v[136:139], v[172:175], v[212:215]
v_mfma_f32_16x16x32_bf16 v[216:219], v[136:139], v[176:179], v[216:219]
v_mfma_f32_16x16x32_bf16 v[220:223], v[136:139], v[180:183], v[220:223]
s_waitcnt lgkmcnt(5)
s_nop 0
v_mfma_f32_16x16x32_bf16 v[208:211], v[140:143], v[164:167], v[208:211]
v_mfma_f32_16x16x32_bf16 v[212:215], v[140:143], v[168:171], v[212:215]
v_mfma_f32_16x16x32_bf16 v[216:219], v[140:143], v[172:175], v[216:219]
v_mfma_f32_16x16x32_bf16 v[220:223], v[140:143], v[176:179], v[220:223]
v_mfma_f32_16x16x32_bf16 v[204:207], v[128:131], v[172:175], v[204:207]
v_mfma_f32_16x16x32_bf16 v[200:203], v[128:131], v[168:171], v[200:203]
v_mfma_f32_16x16x32_bf16 v[196:199], v[128:131], v[164:167], v[196:199]
v_mfma_f32_16x16x32_bf16 v[192:195], v[128:131], v[160:163], v[192:195]
s_waitcnt lgkmcnt(0)
s_nop 0
v_mfma_f32_16x16x32_bf16 v[204:207], v[132:135], v[168:171], v[204:207]
v_add_f32 v208, v208, v224
v_add_f32 v209, v209, v225
v_add_f32 v210, v210, v226
v_add_f32 v211, v211, v227
v_cvt_pk_bf16_f32 v28, v208, v210
v_cvt_pk_bf16_f32 v29, v209, v211
ds_write2st64_b32 v13, v28, v29 offset0:4 offset1:12
v_mfma_f32_16x16x32_bf16 v[200:203], v[132:135], v[164:167], v[200:203]
v_add_f32 v212, v212, v228
v_add_f32 v213, v213, v229
v_add_f32 v214, v214, v230
v_add_f32 v215, v215, v231
v_cvt_pk_bf16_f32 v30, v212, v214
v_cvt_pk_bf16_f32 v31, v213, v215
ds_write2st64_b32 v13, v30, v31 offset0:5 offset1:13
v_mfma_f32_16x16x32_bf16 v[196:199], v[132:135], v[160:163], v[196:199]
v_add_f32 v216, v216, v232
v_add_f32 v217, v217, v233
v_add_f32 v218, v218, v234
v_add_f32 v219, v219, v235
v_cvt_pk_bf16_f32 v32, v216, v218
v_cvt_pk_bf16_f32 v33, v217, v219
ds_write2st64_b32 v13, v32, v33 offset0:6 offset1:14
v_mfma_f32_16x16x32_bf16 v[204:207], v[136:139], v[164:167], v[204:207]
v_add_f32 v220, v220, v236
v_add_f32 v221, v221, v237
v_add_f32 v222, v222, v238
v_add_f32 v223, v223, v239
v_cvt_pk_bf16_f32 v34, v220, v222
v_cvt_pk_bf16_f32 v35, v221, v223
ds_write2st64_b32 v13, v34, v35 offset0:7 offset1:15
v_mfma_f32_16x16x32_bf16 v[200:203], v[136:139], v[160:163], v[200:203]
v_cvt_pk_bf16_f32 v20, v192, v194
v_cvt_pk_bf16_f32 v21, v193, v195
ds_write2st64_b32 v13, v20, v21 offset0:0 offset1:8
v_mfma_f32_16x16x32_bf16 v[204:207], v[140:143], v[160:163], v[204:207]
s_setprio 3
v_cvt_pk_bf16_f32 v22, v196, v198
v_cvt_pk_bf16_f32 v23, v197, v199
ds_write2st64_b32 v13, v22, v23 offset0:1 offset1:9
v_cvt_pk_bf16_f32 v24, v200, v202
v_cvt_pk_bf16_f32 v25, v201, v203
ds_write2st64_b32 v13, v24, v25 offset0:2 offset1:10
s_nop 0
v_cvt_pk_bf16_f32 v26, v204, v206
v_cvt_pk_bf16_f32 v27, v205, v207
ds_write2st64_b32 v13, v26, v27 offset0:3 offset1:11
s_waitcnt lgkmcnt(0)
s_barrier
ds_read_b64_tr_b16 v[40:41], v14 offset:0
ds_read_b64_tr_b16 v[42:43], v14 offset:2048
ds_read_b64_tr_b16 v[44:45], v14 offset:128
ds_read_b64_tr_b16 v[46:47], v14 offset:2176
ds_read_b64_tr_b16 v[48:49], v14 offset:256
ds_read_b64_tr_b16 v[50:51], v14 offset:2304
ds_read_b64_tr_b16 v[52:53], v14 offset:384
ds_read_b64_tr_b16 v[54:55], v14 offset:2432
s_waitcnt lgkmcnt(6)
buffer_store_dwordx4 v[40:43], v15, s[52:55], s50 offen offset:0 sc1
s_waitcnt lgkmcnt(4)
buffer_store_dwordx4 v[44:47], v15, s[52:55], s50 offen offset:1024 sc1
s_waitcnt lgkmcnt(2)
buffer_store_dwordx4 v[48:51], v15, s[52:55], s50 offen offset:2048 sc1
s_waitcnt lgkmcnt(0)
buffer_store_dwordx4 v[52:55], v15, s[52:55], s50 offen offset:3072 sc1
s_lshl_b32 s13, s3, 5
s_add_u32 s13, s13, s4
s_lshl_b32 s13, s13, 2
s_add_u32 s13, s13, 14747600
v_lshlrev_b32 v3, 10, v1
s_waitcnt vmcnt(0)
s_barrier
s_cmp_lg_u32 s5, 0
s_cbranch_scc1 L_C_s
s_bfm_b64 exec, 8, 0
v_mov_b32 v2, 1
buffer_store_dword v2, v3, s[52:55], s13 offen sc1
s_mov_b64 exec, -1
L_C_s:
s_endpgm
L_C_end:
.p2align 3
L_T:
s_setprio 3
s_getpc_b64 s[6:7]
L_T_pc:
s_sub_u32 s8, s4, 0
s_lshl_b32 s8, s8, 2
s_add_u32 s8, s8, s5
s_lshl_b32 s8, s8, 7
s_min_u32 s8, s8, L_T_end-L_T_pc-4
v_mov_b32 v3, s8
global_load_dword v255, v3, s[6:7]
s_lshl_b32 s10, s3, 3
s_add_u32 s10, s10, s4
v_lshrrev_b32 v2, 4, v1
v_and_b32 v3, 15, v1
v_lshlrev_b32 v4, 4, v3
v_mul_u32_u24 v5, 1280, v2
v_add_u32 v5, v5, v4
s_lshl_b32 s11, s10, 2
s_add_u32 s11, s11, s5
s_mul_i32 s12, s11, 10240
s_add_u32 s13, s12, 5120
s_waitcnt lgkmcnt(0)
s_mov_b32 s60, s16
s_mov_b32 s61, s17
s_mov_b32 s62, 2621440
s_mov_b32 s63, 0x20000
s_mov_b32 s64, s42
s_mov_b32 s65, s43
s_mov_b32 s66, 1280
s_mov_b32 s67, 0x20000
s_mov_b32 s52, s48
s_mov_b32 s53, s49
s_mov_b32 s54, 16777216
s_mov_b32 s55, 0x20000
s_mov_b32 s56, s46
s_mov_b32 s57, s47
s_mov_b32 s58, 256
s_mov_b32 s59, 0x20000
buffer_load_dwordx4 v[10:13], v5, s[60:63], s12 offen offset:0
buffer_load_dwordx4 v[14:17], v5, s[60:63], s12 offen offset:256
buffer_load_dwordx4 v[18:21], v5, s[60:63], s12 offen offset:512
buffer_load_dwordx4 v[22:25], v5, s[60:63], s12 offen offset:768
buffer_load_dwordx4 v[26:29], v5, s[60:63], s12 offen offset:1024
buffer_load_dwordx4 v[30:33], v5, s[60:63], s13 offen offset:0
buffer_load_dwordx4 v[34:37], v5, s[60:63], s13 offen offset:256
buffer_load_dwordx4 v[38:41], v5, s[60:63], s13 offen offset:512
buffer_load_dwordx4 v[42:45], v5, s[60:63], s13 offen offset:768
buffer_load_dwordx4 v[46:49], v5, s[60:63], s13 offen offset:1024
buffer_load_dwordx4 v[50:53], v4, s[64:67], 0 offen offset:0
buffer_load_dwordx4 v[54:57], v4, s[64:67], 0 offen offset:256
buffer_load_dwordx4 v[58:61], v4, s[64:67], 0 offen offset:512
buffer_load_dwordx4 v[62:65], v4, s[64:67], 0 offen offset:768
buffer_load_dwordx4 v[66:69], v4, s[64:67], 0 offen offset:1024
s_mul_i32 s14, s5, 10624
v_mul_u32_u24 v6, 1312, v2
v_add3_u32 v6, v6, v4, s14
v_sub_u32 v7, 3, v2
v_mul_u32_u24 v7, 10624, v7
v_bfe_u32 v8, v1, 2, 2
v_sub_u32 v8, 3, v8
v_mul_u32_u24 v8, 1312, v8
v_and_b32 v9, 3, v1
v_lshlrev_b32 v70, 3, v9
s_mul_i32 s14, s5, 320
v_add3_u32 v7, v7, v8, v70
v_add_u32 v7, s14, v7
v_bfe_u32 v8, v1, 2, 2
v_lshlrev_b32 v8, 14, v8
v_lshlrev_b32 v70, 6, v2
v_lshlrev_b32 v9, 4, v9
v_add3_u32 v8, v8, v70, v9
s_mul_i32 s14, s5, 655360
s_lshl_b32 s15, s10, 8
s_sub_u32 s14, s14, s15
s_add_u32 s14, s14, 8404736
s_waitcnt vmcnt(14)
ds_write_b128 v6, v[10:13] offset:0
s_waitcnt vmcnt(13)
ds_write_b128 v6, v[14:17] offset:256
s_waitcnt vmcnt(12)
ds_write_b128 v6, v[18:21] offset:512
s_waitcnt vmcnt(11)
ds_write_b128 v6, v[22:25] offset:768
s_waitcnt vmcnt(10)
ds_write_b128 v6, v[26:29] offset:1024
s_waitcnt vmcnt(9)
ds_write_b128 v6, v[30:33] offset:5248
s_waitcnt vmcnt(8)
ds_write_b128 v6, v[34:37] offset:5504
s_waitcnt vmcnt(7)
ds_write_b128 v6, v[38:41] offset:5760
s_waitcnt vmcnt(6)
ds_write_b128 v6, v[42:45] offset:6016
s_waitcnt vmcnt(5)
ds_write_b128 v6, v[46:49] offset:6272
s_waitcnt lgkmcnt(0)
s_barrier
ds_read_b64_tr_b16 v[72:73], v7 offset:5248
ds_read_b64_tr_b16 v[74:75], v7 offset:0
ds_read_b64_tr_b16 v[76:77], v7 offset:5280
ds_read_b64_tr_b16 v[78:79], v7 offset:32
ds_read_b64_tr_b16 v[80:81], v7 offset:5312
ds_read_b64_tr_b16 v[82:83], v7 offset:64
ds_read_b64_tr_b16 v[84:85], v7 offset:5344
ds_read_b64_tr_b16 v[86:87], v7 offset:96
s_waitcnt lgkmcnt(6)
buffer_store_dwordx4 v[72:75], v8, s[52:55], s14 offen sc1
s_add_u32 s14, s14, 65536
ds_read_b64_tr_b16 v[88:89], v7 offset:5376
ds_read_b64_tr_b16 v[90:91], v7 offset:128
s_waitcnt lgkmcnt(6)
buffer_store_dwordx4 v[76:79], v8, s[52:55], s14 offen sc1
s_add_u32 s14, s14, 65536
ds_read_b64_tr_b16 v[92:93], v7 offset:5408
ds_read_b64_tr_b16 v[94:95], v7 offset:160
s_waitcnt lgkmcnt(6)
buffer_store_dwordx4 v[80:83], v8, s[52:55], s14 offen sc1
s_add_u32 s14, s14, 65536
ds_read_b64_tr_b16 v[96:97], v7 offset:5440
ds_read_b64_tr_b16 v[98:99], v7 offset:192
s_waitcnt lgkmcnt(6)
buffer_store_dwordx4 v[84:87], v8, s[52:55], s14 offen sc1
s_add_u32 s14, s14, 65536
ds_read_b64_tr_b16 v[100:101], v7 offset:5472
ds_read_b64_tr_b16 v[102:103], v7 offset:224
s_waitcnt lgkmcnt(6)
buffer_store_dwordx4 v[88:91], v8, s[52:55], s14 offen sc1
s_add_u32 s14, s14, 65536
ds_read_b64_tr_b16 v[104:105], v7 offset:5504
ds_read_b64_tr_b16 v[106:107], v7 offset:256
s_waitcnt lgkmcnt(6)
buffer_store_dwordx4 v[92:95], v8, s[52:55], s14 offen sc1
s_add_u32 s14, s14, 65536
ds_read_b64_tr_b16 v[108:109], v7 offset:5536
ds_read_b64_tr_b16 v[110:111], v7 offset:288
s_waitcnt lgkmcnt(6)
buffer_store_dwordx4 v[96:99], v8, s[52:55], s14 offen sc1
s_add_u32 s14, s14, 65536
s_waitcnt lgkmcnt(4)
buffer_store_dwordx4 v[100:103], v8, s[52:55], s14 offen sc1
s_add_u32 s14, s14, 65536
s_waitcnt lgkmcnt(2)
buffer_store_dwordx4 v[104:107], v8, s[52:55], s14 offen sc1
s_add_u32 s14, s14, 65536
s_waitcnt lgkmcnt(0)
buffer_store_dwordx4 v[108:111], v8, s[52:55], s14 offen sc1
s_add_u32 s14, s14, 65536
s_waitcnt vmcnt(10)
v_mov_b32 v112, 0
v_mov_b32 v113, 0
s_mov_b32 s15, 0xffff0000
v_lshlrev_b32 v121, 16, v50
v_and_b32 v122, s15, v50
v_lshlrev_b32 v123, 16, v10
v_and_b32 v10, s15, v10
v_fmac_f32 v112, v123, v121
v_fmac_f32 v112, v10, v122
v_lshlrev_b32 v123, 16, v30
v_and_b32 v30, s15, v30
v_fmac_f32 v113, v123, v121
v_fmac_f32 v113, v30, v122
v_lshlrev_b32 v121, 16, v51
v_and_b32 v122, s15, v51
v_lshlrev_b32 v123, 16, v11
v_and_b32 v11, s15, v11
v_fmac_f32 v112, v123, v121
v_fmac_f32 v112, v11, v122
v_lshlrev_b32 v123, 16, v31
v_and_b32 v31, s15, v31
v_fmac_f32 v113, v123, v121
v_fmac_f32 v113, v31, v122
v_lshlrev_b32 v121, 16, v52
v_and_b32 v122, s15, v52
v_lshlrev_b32 v123, 16, v12
v_and_b32 v12, s15, v12
v_fmac_f32 v112, v123, v121
v_fmac_f32 v112, v12, v122
v_lshlrev_b32 v123, 16, v32
v_and_b32 v32, s15, v32
v_fmac_f32 v113, v123, v121
v_fmac_f32 v113, v32, v122
v_lshlrev_b32 v121, 16, v53
v_and_b32 v122, s15, v53
v_lshlrev_b32 v123, 16, v13
v_and_b32 v13, s15, v13
v_fmac_f32 v112, v123, v121
v_fmac_f32 v112, v13, v122
v_lshlrev_b32 v123, 16, v33
v_and_b32 v33, s15, v33
v_fmac_f32 v113, v123, v121
v_fmac_f32 v113, v33, v122
v_lshlrev_b32 v121, 16, v54
v_and_b32 v122, s15, v54
v_lshlrev_b32 v123, 16, v14
v_and_b32 v14, s15, v14
v_fmac_f32 v112, v123, v121
v_fmac_f32 v112, v14, v122
v_lshlrev_b32 v123, 16, v34
v_and_b32 v34, s15, v34
v_fmac_f32 v113, v123, v121
v_fmac_f32 v113, v34, v122
v_lshlrev_b32 v121, 16, v55
v_and_b32 v122, s15, v55
v_lshlrev_b32 v123, 16, v15
v_and_b32 v15, s15, v15
v_fmac_f32 v112, v123, v121
v_fmac_f32 v112, v15, v122
v_lshlrev_b32 v123, 16, v35
v_and_b32 v35, s15, v35
v_fmac_f32 v113, v123, v121
v_fmac_f32 v113, v35, v122
v_lshlrev_b32 v121, 16, v56
v_and_b32 v122, s15, v56
v_lshlrev_b32 v123, 16, v16
v_and_b32 v16, s15, v16
v_fmac_f32 v112, v123, v121
v_fmac_f32 v112, v16, v122
v_lshlrev_b32 v123, 16, v36
v_and_b32 v36, s15, v36
v_fmac_f32 v113, v123, v121
v_fmac_f32 v113, v36, v122
v_lshlrev_b32 v121, 16, v57
v_and_b32 v122, s15, v57
v_lshlrev_b32 v123, 16, v17
v_and_b32 v17, s15, v17
v_fmac_f32 v112, v123, v121
v_fmac_f32 v112, v17, v122
v_lshlrev_b32 v123, 16, v37
v_and_b32 v37, s15, v37
v_fmac_f32 v113, v123, v121
v_fmac_f32 v113, v37, v122
v_lshlrev_b32 v121, 16, v58
v_and_b32 v122, s15, v58
v_lshlrev_b32 v123, 16, v18
v_and_b32 v18, s15, v18
v_fmac_f32 v112, v123, v121
v_fmac_f32 v112, v18, v122
v_lshlrev_b32 v123, 16, v38
v_and_b32 v38, s15, v38
v_fmac_f32 v113, v123, v121
v_fmac_f32 v113, v38, v122
v_lshlrev_b32 v121, 16, v59
v_and_b32 v122, s15, v59
v_lshlrev_b32 v123, 16, v19
v_and_b32 v19, s15, v19
v_fmac_f32 v112, v123, v121
v_fmac_f32 v112, v19, v122
v_lshlrev_b32 v123, 16, v39
v_and_b32 v39, s15, v39
v_fmac_f32 v113, v123, v121
v_fmac_f32 v113, v39, v122
v_lshlrev_b32 v121, 16, v60
v_and_b32 v122, s15, v60
v_lshlrev_b32 v123, 16, v20
v_and_b32 v20, s15, v20
v_fmac_f32 v112, v123, v121
v_fmac_f32 v112, v20, v122
v_lshlrev_b32 v123, 16, v40
v_and_b32 v40, s15, v40
v_fmac_f32 v113, v123, v121
v_fmac_f32 v113, v40, v122
v_lshlrev_b32 v121, 16, v61
v_and_b32 v122, s15, v61
v_lshlrev_b32 v123, 16, v21
v_and_b32 v21, s15, v21
v_fmac_f32 v112, v123, v121
v_fmac_f32 v112, v21, v122
v_lshlrev_b32 v123, 16, v41
v_and_b32 v41, s15, v41
v_fmac_f32 v113, v123, v121
v_fmac_f32 v113, v41, v122
v_lshlrev_b32 v121, 16, v62
v_and_b32 v122, s15, v62
v_lshlrev_b32 v123, 16, v22
v_and_b32 v22, s15, v22
v_fmac_f32 v112, v123, v121
v_fmac_f32 v112, v22, v122
v_lshlrev_b32 v123, 16, v42
v_and_b32 v42, s15, v42
v_fmac_f32 v113, v123, v121
v_fmac_f32 v113, v42, v122
v_lshlrev_b32 v121, 16, v63
v_and_b32 v122, s15, v63
v_lshlrev_b32 v123, 16, v23
v_and_b32 v23, s15, v23
v_fmac_f32 v112, v123, v121
v_fmac_f32 v112, v23, v122
v_lshlrev_b32 v123, 16, v43
v_and_b32 v43, s15, v43
v_fmac_f32 v113, v123, v121
v_fmac_f32 v113, v43, v122
v_lshlrev_b32 v121, 16, v64
v_and_b32 v122, s15, v64
v_lshlrev_b32 v123, 16, v24
v_and_b32 v24, s15, v24
v_fmac_f32 v112, v123, v121
v_fmac_f32 v112, v24, v122
v_lshlrev_b32 v123, 16, v44
v_and_b32 v44, s15, v44
v_fmac_f32 v113, v123, v121
v_fmac_f32 v113, v44, v122
v_lshlrev_b32 v121, 16, v65
v_and_b32 v122, s15, v65
v_lshlrev_b32 v123, 16, v25
v_and_b32 v25, s15, v25
v_fmac_f32 v112, v123, v121
v_fmac_f32 v112, v25, v122
v_lshlrev_b32 v123, 16, v45
v_and_b32 v45, s15, v45
v_fmac_f32 v113, v123, v121
v_fmac_f32 v113, v45, v122
v_lshlrev_b32 v121, 16, v66
v_and_b32 v122, s15, v66
v_lshlrev_b32 v123, 16, v26
v_and_b32 v26, s15, v26
v_fmac_f32 v112, v123, v121
v_fmac_f32 v112, v26, v122
v_lshlrev_b32 v123, 16, v46
v_and_b32 v46, s15, v46
v_fmac_f32 v113, v123, v121
v_fmac_f32 v113, v46, v122
v_lshlrev_b32 v121, 16, v67
v_and_b32 v122, s15, v67
v_lshlrev_b32 v123, 16, v27
v_and_b32 v27, s15, v27
v_fmac_f32 v112, v123, v121
v_fmac_f32 v112, v27, v122
v_lshlrev_b32 v123, 16, v47
v_and_b32 v47, s15, v47
v_fmac_f32 v113, v123, v121
v_fmac_f32 v113, v47, v122
v_lshlrev_b32 v121, 16, v68
v_and_b32 v122, s15, v68
v_lshlrev_b32 v123, 16, v28
v_and_b32 v28, s15, v28
v_fmac_f32 v112, v123, v121
v_fmac_f32 v112, v28, v122
v_lshlrev_b32 v123, 16, v48
v_and_b32 v48, s15, v48
v_fmac_f32 v113, v123, v121
v_fmac_f32 v113, v48, v122
v_lshlrev_b32 v121, 16, v69
v_and_b32 v122, s15, v69
v_lshlrev_b32 v123, 16, v29
v_and_b32 v29, s15, v29
v_fmac_f32 v112, v123, v121
v_fmac_f32 v112, v29, v122
v_lshlrev_b32 v123, 16, v49
v_and_b32 v49, s15, v49
v_fmac_f32 v113, v123, v121
v_fmac_f32 v113, v49, v122
v_add_f32_dpp v112, v112, v112 row_ror:8 row_mask:0xf bank_mask:0xf
s_nop 0
v_add_f32_dpp v113, v113, v113 row_ror:8 row_mask:0xf bank_mask:0xf
v_add_f32_dpp v112, v112, v112 row_ror:4 row_mask:0xf bank_mask:0xf
s_nop 0
v_add_f32_dpp v113, v113, v113 row_ror:4 row_mask:0xf bank_mask:0xf
v_add_f32_dpp v112, v112, v112 row_ror:2 row_mask:0xf bank_mask:0xf
s_nop 0
v_add_f32_dpp v113, v113, v113 row_ror:2 row_mask:0xf bank_mask:0xf
v_add_f32_dpp v112, v112, v112 row_ror:1 row_mask:0xf bank_mask:0xf
s_nop 0
v_add_f32_dpp v113, v113, v113 row_ror:1 row_mask:0xf bank_mask:0xf
v_cvt_pk_bf16_f32 v114, v112, v113
v_lshlrev_b32 v112, 16, v114
v_and_b32 v113, 0xffff0000, v114
v_mul_f32 v112, 0xbfb8aa3b, v112
v_mul_f32 v113, 0xbfb8aa3b, v113
v_exp_f32 v112, v112
v_exp_f32 v113, v113
v_add_f32 v112, 1.0, v112
v_add_f32 v113, 1.0, v113
v_rcp_f32 v112, v112
v_rcp_f32 v113, v113
s_nop 0
v_cvt_pk_bf16_f32 v114, v112, v113
v_lshlrev_b32 v116, 16, v114
v_and_b32 v118, 0xffff0000, v114
v_sub_f32 v112, 1.0, v116
v_sub_f32 v113, 1.0, v118
v_cvt_pk_bf16_f32 v114, v112, v113
v_lshlrev_b32 v117, 16, v114
v_and_b32 v119, 0xffff0000, v114
s_lshl_b32 s11, s11, 6
s_add_u32 s11, s11, 14680064
v_lshlrev_b32 v2, 3, v2
s_mov_b32 exec_lo, 0x10001
s_mov_b32 exec_hi, 0x10001
buffer_store_dwordx2 v[116:117], v2, s[52:55], s11 offen sc1
buffer_store_dwordx2 v[118:119], v2, s[52:55], s11 offen offset:32 sc1
s_mov_b64 exec, -1
s_cmp_lg_u32 s5, 0
s_cbranch_scc1 L_T_i
s_bfm_b64 exec, 1, 0
buffer_load_dword v120, off, s[56:59], 0 sc1
s_mov_b64 exec, -1
L_T_i:
s_lshl_b32 s10, s10, 2
s_add_u32 s10, s10, 14755840
v_lshlrev_b32 v3, 8, v1
s_waitcnt vmcnt(0)
s_barrier
s_cmp_lg_u32 s5, 0
s_cbranch_scc1 L_T_s
s_bfm_b64 exec, 1, 0
s_mov_b32 s8, 0
L_T_I_l:
v_cmp_eq_u32 vcc, 0, v120
s_add_u32 s8, s8, 1
s_cbranch_vccz L_T_I_d
s_cmp_ge_u32 s8, 200000
s_cbranch_scc1 L_T_I_d
buffer_load_dword v120, off, s[56:59], 0 sc1
s_waitcnt vmcnt(0)
s_branch L_T_I_l
L_T_I_d:
s_mov_b64 exec, 0xff
v_mov_b32 v2, 1
buffer_store_dword v2, v3, s[52:55], s10 offen sc1
s_mov_b64 exec, -1
L_T_s:
s_endpgm
L_T_end:
.p2align 3
L_W:
s_setprio 2
s_getpc_b64 s[6:7]
L_W_pc:
s_sub_u32 s8, s4, 8
s_lshl_b32 s8, s8, 2
s_add_u32 s8, s8, s5
s_lshl_b32 s8, s8, 7
s_min_u32 s8, s8, L_W_end-L_W_pc-4
v_mov_b32 v3, s8
global_load_dword v255, v3, s[6:7]
s_lshl_b32 s10, s3, 2
s_add_u32 s10, s10, s4
s_sub_u32 s10, s10, 8
v_lshrrev_b32 v2, 4, v1
v_and_b32 v3, 15, v1
v_lshlrev_b32 v4, 4, v3
v_mul_u32_u24 v5, 1280, v2
v_add_u32 v5, v5, v4
s_lshl_b32 s11, s10, 2
s_add_u32 s11, s11, s5
s_mul_i32 s12, s11, 15360
s_add_u32 s13, s12, 5120
s_add_u32 s14, s12, 10240
s_waitcnt lgkmcnt(0)
s_mov_b32 s60, s40
s_mov_b32 s61, s41
s_mov_b32 s62, 1966080
s_mov_b32 s63, 0x20000
s_mov_b32 s52, s48
s_mov_b32 s53, s49
s_mov_b32 s54, 16777216
s_mov_b32 s55, 0x20000
s_mov_b32 s56, s46
s_mov_b32 s57, s47
s_mov_b32 s58, 256
s_mov_b32 s59, 0x20000
s_cmp_lg_u32 s10, 0
s_cbranch_scc1 L_W_y
v_mov_b32 v72, 0
v_mov_b32 v73, 0
v_mov_b32 v74, 0
v_mov_b32 v75, 0
v_lshlrev_b32 v76, 4, v0
s_mov_b32 s15, 14745600
buffer_load_dword v78, off, s[56:59], 0 sc1
buffer_store_dwordx4 v[72:75], v76, s[52:55], s15 offen sc1
s_add_u32 s15, s15, 4096
buffer_store_dwordx4 v[72:75], v76, s[52:55], s15 offen sc1
s_add_u32 s15, s15, 4096
buffer_store_dwordx4 v[72:75], v76, s[52:55], s15 offen sc1
s_add_u32 s15, s15, 4096
buffer_store_dwordx4 v[72:75], v76, s[52:55], s15 offen sc1
s_add_u32 s15, s15, 4096
v_lshlrev_b32 v76, 7, v0
buffer_store_dword v72, v76, s[52:55], s15 offen sc1
L_W_y:
buffer_load_dwordx4 v[10:13], v5, s[60:63], s12 offen offset:0
s_waitcnt vmcnt(0)
s_cmp_lg_u32 s10, 0
s_cbranch_scc1 L_W_z
s_barrier
s_cmp_lg_u32 s5, 0
s_cbranch_scc1 L_W_z
s_bfm_b64 exec, 1, 0
v_mov_b32 v77, 1
buffer_store_dword v77, off, s[56:59], 0 sc1
s_mov_b64 exec, -1
L_W_z:
buffer_load_dwordx4 v[14:17], v5, s[60:63], s12 offen offset:256
buffer_load_dwordx4 v[18:21], v5, s[60:63], s12 offen offset:512
buffer_load_dwordx4 v[22:25], v5, s[60:63], s12 offen offset:768
buffer_load_dwordx4 v[26:29], v5, s[60:63], s12 offen offset:1024
buffer_load_dwordx4 v[30:33], v5, s[60:63], s13 offen offset:0
buffer_load_dwordx4 v[34:37], v5, s[60:63], s13 offen offset:256
buffer_load_dwordx4 v[38:41], v5, s[60:63], s13 offen offset:512
buffer_load_dwordx4 v[42:45], v5, s[60:63], s13 offen offset:768
buffer_load_dwordx4 v[46:49], v5, s[60:63], s13 offen offset:1024
buffer_load_dwordx4 v[50:53], v5, s[60:63], s14 offen offset:0
buffer_load_dwordx4 v[54:57], v5, s[60:63], s14 offen offset:256
buffer_load_dwordx4 v[58:61], v5, s[60:63], s14 offen offset:512
buffer_load_dwordx4 v[62:65], v5, s[60:63], s14 offen offset:768
buffer_load_dwordx4 v[66:69], v5, s[60:63], s14 offen offset:1024
s_mul_i32 s15, s5, 15744
v_mul_u32_u24 v6, 1312, v2
v_add3_u32 v6, v6, v4, s15
v_bfe_u32 v7, v1, 2, 3
v_mul_u32_u24 v7, 1312, v7
v_lshrrev_b32 v8, 5, v1
v_mul_u32_u24 v9, 640, v8
v_and_b32 v70, 3, v1
v_lshlrev_b32 v70, 3, v70
s_mul_i32 s15, s5, 160
v_add3_u32 v7, v7, v9, v70
v_add_u32 v7, s15, v7
v_mul_u32_u24 v8, 983040, v8
v_and_b32 v9, 31, v1
v_lshlrev_b32 v9, 4, v9
v_add_u32 v8, v8, v9
v_add_u32 v9, 4096, v8
s_mul_i32 s12, s10, 3
s_add_u32 s12, s12, 0
s_and_b32 s15, s12, 1
s_lshl_b32 s15, s15, 9
s_lshr_b32 s12, s12, 1
s_mul_i32 s12, s12, 5120
s_add_u32 s12, s12, s15
s_mul_i32 s15, s5, 245760
s_add_u32 s15, s15, 6291456
s_add_u32 s12, s12, s15
s_mul_i32 s13, s10, 3
s_add_u32 s13, s13, 1
s_and_b32 s15, s13, 1
s_lshl_b32 s15, s15, 9
s_lshr_b32 s13, s13, 1
s_mul_i32 s13, s13, 5120
s_add_u32 s13, s13, s15
s_mul_i32 s15, s5, 245760
s_add_u32 s15, s15, 6291456
s_add_u32 s13, s13, s15
s_mul_i32 s14, s10, 3
s_add_u32 s14, s14, 2
s_and_b32 s15, s14, 1
s_lshl_b32 s15, s15, 9
s_lshr_b32 s14, s14, 1
s_mul_i32 s14, s14, 5120
s_add_u32 s14, s14, s15
s_mul_i32 s15, s5, 245760
s_add_u32 s15, s15, 6291456
s_add_u32 s14, s14, s15
ds_write_b128 v6, v[10:13] offset:0
s_waitcnt vmcnt(13)
ds_write_b128 v6, v[14:17] offset:256
s_waitcnt vmcnt(12)
ds_write_b128 v6, v[18:21] offset:512
s_waitcnt vmcnt(11)
ds_write_b128 v6, v[22:25] offset:768
s_waitcnt vmcnt(10)
ds_write_b128 v6, v[26:29] offset:1024
s_waitcnt vmcnt(9)
ds_write_b128 v6, v[30:33] offset:5248
s_waitcnt vmcnt(8)
ds_write_b128 v6, v[34:37] offset:5504
s_waitcnt vmcnt(7)
ds_write_b128 v6, v[38:41] offset:5760
s_waitcnt vmcnt(6)
ds_write_b128 v6, v[42:45] offset:6016
s_waitcnt vmcnt(5)
ds_write_b128 v6, v[46:49] offset:6272
s_waitcnt vmcnt(4)
ds_write_b128 v6, v[50:53] offset:10496
s_waitcnt vmcnt(3)
ds_write_b128 v6, v[54:57] offset:10752
s_waitcnt vmcnt(2)
ds_write_b128 v6, v[58:61] offset:11008
s_waitcnt vmcnt(1)
ds_write_b128 v6, v[62:65] offset:11264
s_waitcnt vmcnt(0)
ds_write_b128 v6, v[66:69] offset:11520
s_waitcnt lgkmcnt(0)
s_barrier
ds_read_b64_tr_b16 v[72:73], v7 offset:0
ds_read_b64_tr_b16 v[74:75], v7 offset:10496
ds_read_b64_tr_b16 v[76:77], v7 offset:32
ds_read_b64_tr_b16 v[78:79], v7 offset:10528
ds_read_b64_tr_b16 v[80:81], v7 offset:64
ds_read_b64_tr_b16 v[82:83], v7 offset:10560
ds_read_b64_tr_b16 v[84:85], v7 offset:96
ds_read_b64_tr_b16 v[86:87], v7 offset:10592
s_waitcnt lgkmcnt(6)
buffer_store_dwordx4 v[72:75], v8, s[52:55], s12 offen offset:0 sc1
ds_read_b64_tr_b16 v[88:89], v7 offset:128
ds_read_b64_tr_b16 v[90:91], v7 offset:10624
s_waitcnt lgkmcnt(6)
buffer_store_dwordx4 v[76:79], v8, s[52:55], s12 offen offset:1024 sc1
ds_read_b64_tr_b16 v[92:93], v7 offset:20992
ds_read_b64_tr_b16 v[94:95], v7 offset:31488
s_waitcnt lgkmcnt(6)
buffer_store_dwordx4 v[80:83], v8, s[52:55], s12 offen offset:2048 sc1
ds_read_b64_tr_b16 v[96:97], v7 offset:21024
ds_read_b64_tr_b16 v[98:99], v7 offset:31520
s_waitcnt lgkmcnt(6)
buffer_store_dwordx4 v[84:87], v8, s[52:55], s12 offen offset:3072 sc1
ds_read_b64_tr_b16 v[100:101], v7 offset:21056
ds_read_b64_tr_b16 v[102:103], v7 offset:31552
s_waitcnt lgkmcnt(6)
buffer_store_dwordx4 v[88:91], v9, s[52:55], s12 offen offset:0 sc1
ds_read_b64_tr_b16 v[104:105], v7 offset:21088
ds_read_b64_tr_b16 v[106:107], v7 offset:31584
s_waitcnt lgkmcnt(6)
buffer_store_dwordx4 v[92:95], v8, s[52:55], s13 offen offset:0 sc1
ds_read_b64_tr_b16 v[108:109], v7 offset:21120
ds_read_b64_tr_b16 v[110:111], v7 offset:31616
s_waitcnt lgkmcnt(6)
buffer_store_dwordx4 v[96:99], v8, s[52:55], s13 offen offset:1024 sc1
ds_read_b64_tr_b16 v[112:113], v7 offset:41984
ds_read_b64_tr_b16 v[114:115], v7 offset:52480
s_waitcnt lgkmcnt(6)
buffer_store_dwordx4 v[100:103], v8, s[52:55], s13 offen offset:2048 sc1
ds_read_b64_tr_b16 v[116:117], v7 offset:42016
ds_read_b64_tr_b16 v[118:119], v7 offset:52512
s_waitcnt lgkmcnt(6)
buffer_store_dwordx4 v[104:107], v8, s[52:55], s13 offen offset:3072 sc1
ds_read_b64_tr_b16 v[120:121], v7 offset:42048
ds_read_b64_tr_b16 v[122:123], v7 offset:52544
s_waitcnt lgkmcnt(6)
buffer_store_dwordx4 v[108:111], v9, s[52:55], s13 offen offset:0 sc1
ds_read_b64_tr_b16 v[124:125], v7 offset:42080
ds_read_b64_tr_b16 v[126:127], v7 offset:52576
s_waitcnt lgkmcnt(6)
buffer_store_dwordx4 v[112:115], v8, s[52:55], s14 offen offset:0 sc1
ds_read_b64_tr_b16 v[128:129], v7 offset:42112
ds_read_b64_tr_b16 v[130:131], v7 offset:52608
s_waitcnt lgkmcnt(6)
buffer_store_dwordx4 v[116:119], v8, s[52:55], s14 offen offset:1024 sc1
s_waitcnt lgkmcnt(4)
buffer_store_dwordx4 v[120:123], v8, s[52:55], s14 offen offset:2048 sc1
s_waitcnt lgkmcnt(2)
buffer_store_dwordx4 v[124:127], v8, s[52:55], s14 offen offset:3072 sc1
s_waitcnt lgkmcnt(0)
buffer_store_dwordx4 v[128:131], v9, s[52:55], s14 offen offset:0 sc1
s_cmp_lg_u32 s5, 0
s_cbranch_scc1 L_W_i
s_bfm_b64 exec, 1, 0
buffer_load_dword v140, off, s[56:59], 0 sc1
s_mov_b64 exec, -1
L_W_i:
s_lshl_b32 s10, s10, 2
s_add_u32 s10, s10, 14757888
v_lshlrev_b32 v3, 7, v1
s_waitcnt vmcnt(0)
s_barrier
s_cmp_lg_u32 s5, 0
s_cbranch_scc1 L_W_s
s_bfm_b64 exec, 1, 0
s_mov_b32 s8, 0
L_W_I_l:
v_cmp_eq_u32 vcc, 0, v140
s_add_u32 s8, s8, 1
s_cbranch_vccz L_W_I_d
s_cmp_ge_u32 s8, 200000
s_cbranch_scc1 L_W_I_d
buffer_load_dword v140, off, s[56:59], 0 sc1
s_waitcnt vmcnt(0)
s_branch L_W_I_l
L_W_I_d:
s_mov_b64 exec, 0xff
v_mov_b32 v2, 1
buffer_store_dword v2, v3, s[52:55], s10 offen sc1
s_mov_b64 exec, -1
L_W_s:
s_endpgm
L_W_end:
.section .rodata,"a"
.p2align 6
.amdhsa_kernel gated_mix__ssm_conv_s4__glu_gated_bilinear__prompt_kernel
  .amdhsa_next_free_vgpr 256
  .amdhsa_next_free_sgpr 102
  .amdhsa_accum_offset 256
  .amdhsa_group_segment_fixed_size 0
  .amdhsa_kernarg_size 136
  .amdhsa_user_sgpr_count 2
  .amdhsa_user_sgpr_kernarg_segment_ptr 1
  .amdhsa_system_sgpr_workgroup_id_x 1
.end_amdhsa_kernel
```
